```python
import torch

def _softmax(x, axis=-1):
    return torch.softmax(x, dim=axis)
def _gelu(x):
    return torch.nn.functional.gelu(x, approximate="tanh")
def _silu(x):
    return torch.nn.functional.silu(x)
def _sigmoid(x):
    return torch.sigmoid(x)
def _layernorm(x, axis=-1, eps=1e-5):
    m = x.mean(dim=axis, keepdim=True)
    v = x.var(dim=axis, keepdim=True, unbiased=False)
    return (x - m) / torch.sqrt(v + eps)
def _scatter_add(tgt, idx, src, axis=0):
    return tgt.clone().index_add_(axis, idx, src)
def _segment_sum(src, seg, n):
    out = torch.zeros((n,) + src.shape[1:], dtype=src.dtype)
    return out.index_add_(0, seg, src)
def _pad(x, pw):
    flat = tuple(v for pair in reversed(pw) for v in pair)
    return torch.nn.functional.pad(x, flat)

kernel_name = 'sequential_preLN__linear_kernel_hedgehog__mixer_channel_mlp__prompt'

def setup_inputs():

    _w = (lambda a: (lambda t: t.to(torch.bfloat16) if t.is_floating_point() else t)(torch.as_tensor(a)))
    def _A_setup():
        B, S, D, H = 1, 2048, 448, 16
        Dh = D // H
        return {
            "x": _w((lambda *s: torch.randn(*s, dtype=torch.bfloat16) * 0.05)(B, S, D)),
            "wqkv": _w((lambda *s: torch.randn(*s, dtype=torch.bfloat16) * 0.2)(D, 3 * D)),
            "w_phi": _w((lambda *s: torch.randn(*s, dtype=torch.bfloat16) * 0.2)(H, Dh, Dh) * (Dh ** -0.5)),
            "wo": _w((lambda *s: torch.randn(*s, dtype=torch.bfloat16) * 0.05)(D, D)),
        }
    _A_in = _A_setup()

    def _B_setup():
        B, S, D, F = 1, 2048, 448, 1792
        return {
            "x": _w((lambda *s: torch.randn(*s, dtype=torch.bfloat16) * 0.05)(B, S, D)),
            "w1": _w((lambda *s: torch.randn(*s, dtype=torch.bfloat16) * 3.2)(D, F) * (D ** -0.5)),
            "b1": _w((lambda *s: torch.randn(*s, dtype=torch.bfloat16) * 0.8)(F)),
            "w2": _w((lambda *s: torch.randn(*s, dtype=torch.bfloat16) * 0.1)(F, D) * (F ** -0.5)),
            "b2": _w((lambda *s: torch.randn(*s, dtype=torch.bfloat16) * 0.1)(D)),
        }
    _B_in = _B_setup()

    return {
        "A_x": _A_in["x"],
        "A_wqkv": _A_in["wqkv"],
        "A_w_phi": _A_in["w_phi"],
        "A_wo": _A_in["wo"],
        "B_x": _B_in["x"],
        "B_w1": _B_in["w1"],
        "B_b1": _B_in["b1"],
        "B_w2": _B_in["w2"],
        "B_b2": _B_in["b2"],
    }

def reference(A_x, A_wqkv, A_w_phi, A_wo, B_x, B_w1, B_b1, B_w2, B_b2):
    def _A_ref(x, wqkv, w_phi, wo):
        B, S, D = x.shape
        H = 16; Dh = D // H
        qkv = (lambda x, *d: x.permute(*d))((x @ wqkv).reshape(B, S, 3, H, Dh), 2, 0, 3, 1, 4)
        q, k, v = qkv[0], qkv[1], qkv[2]
        pq = torch.einsum("bhsd,hdf->bhsf", q, w_phi)
        pk = torch.einsum("bhsd,hdf->bhsf", k, w_phi)
        phi_q = torch.concatenate([_softmax(pq, axis=-1), _softmax(-pq, axis=-1)], axis=-1)
        phi_k = torch.concatenate([_softmax(pk, axis=-1), _softmax(-pk, axis=-1)], axis=-1)
        kv = torch.einsum("bhsf,bhsd->bhfd", phi_k, v)
        z  = torch.einsum("bhsf->bhf", phi_k)
        num = torch.einsum("bhqf,bhfd->bhqd", phi_q, kv)
        den = torch.einsum("bhqf,bhf->bhq", phi_q, z)[..., None] + 1e-6
        o = num / den
        return (lambda x, *d: x.permute(*d))(o, 0, 2, 1, 3).reshape(B, S, D) @ wo

    def _B_ref(x, w1, b1, w2, b2):
        y = _layernorm(x, axis=-1)
        h = _gelu(torch.einsum("bsd,df->bsf", y, w1) + b1)
        return torch.einsum("bsf,fd->bsd", h, w2) + b2

    x = A_x
    h = x + _A_ref(_layernorm(x, axis=-1), A_wqkv, A_w_phi, A_wo)
    h2 = h + _B_ref(_layernorm(h, axis=-1), B_w1, B_b1, B_w2, B_b2)
    return h2
```

```asm
; @launch grid=(256,1,1) block=(256,1,1) lds=163840
.amdgcn_target "amdgcn-amd-amdhsa--gfx950"
.text
.globl sequential_preLN__linear_kernel_hedgehog__mixer_channel_mlp__prompt_kernel
.p2align 8
.type sequential_preLN__linear_kernel_hedgehog__mixer_channel_mlp__prompt_kernel,@function
sequential_preLN__linear_kernel_hedgehog__mixer_channel_mlp__prompt_kernel:
    s_cmp_ge_u32 s2, 256
    s_cbranch_scc1 L_end
    s_load_dwordx16 s[16:31], s[0:1], 0
    s_load_dwordx8 s[32:39], s[0:1], 64
    s_getpc_b64 s[96:97]
L_pc:
    v_lshrrev_b32 v1, 6, v0
    s_lshr_b32 s3, s2, 3
    v_readfirstlane_b32 s4, v1
    v_and_b32 v1, 63, v0
    s_and_b32 s13, s2, 3
    s_lshl_b32 s13, s13, 2
    s_and_b32 s6, s3, 3
    s_lshr_b32 s5, s3, 2
    s_lshl_b32 s86, s6, 1
    s_add_u32 s86, s86, s5
    s_sub_u32 s14, s86, 7
    s_cmp_ge_u32 s86, 7
    s_cselect_b32 s86, s14, s86
    s_add_u32 s6, s6, s13
    s_and_b32 s13, s2, 4
    s_lshl_b32 s13, s13, 1
    s_add_u32 s5, s5, s13
    s_lshl_b32 s7, s6, 2
    s_add_u32 s7, s7, s4
    v_lshrrev_b32 v2, 3, v1
    v_mul_u32_u24 v5, 896, v2
    v_and_b32 v3, 7, v1
    v_lshrrev_b32 v4, 4, v1
    v_xor_b32 v3, v3, v4
    v_lshl_add_u32 v44, v3, 4, v5
    v_xor_b32 v45, 64, v44
    v_add_u32 v45, 6144, v45
    v_add_u32 v46, 12288, v44
    v_add_u32 v47, 12288, v45
    v_lshrrev_b32 v2, 2, v1
    v_mul_u32_u24 v2, 2688, v2
    v_and_b32 v3, 3, v1
    v_lshl_add_u32 v50, v3, 4, v2
    v_add_u32 v48, 896, v50
    s_mul_i32 s89, s7, 28672
    s_add_u32 s90, s89, 896
    s_lshl_b32 s12, s86, 7
    s_add_u32 s84, s89, s12
    s_mul_i32 s14, s5, 56
    s_cmp_eq_u32 s5, 15
    s_cselect_b32 s87, 8, 0
    s_sub_u32 s14, s14, s87
    s_mul_i32 s91, s4, 43008
    s_add_u32 s91, s91, s14
    s_mul_i32 s12, s86, 172032
    s_add_u32 s85, s91, s12
    s_mov_b32 s93, s85
    s_add_u32 s94, s91, 1204224
    s_lshl_b32 s88, s4, 14
    s_add_u32 s88, s88, 86016
    s_lshl_b32 s15, s4, 10
    s_mov_b32 s42, 1835008
    s_mov_b32 s43, 0x00020000
    s_mov_b32 s46, 1204224
    s_mov_b32 s47, 0x00020000
    s_and_b32 s13, s3, 7
    s_lshl_b32 s13, s13, 2
    s_add_u32 s13, s13, s4
    s_lshl_b32 s13, s13, 10
    v_and_b32 v2, 7, v1
    v_lshl_add_u32 v2, v2, 7, s13
    v_min_u32 v2, L_end-L_pc, v2
    global_load_dword a116, v2, s[96:97]
    s_waitcnt lgkmcnt(0)
    s_mov_b64 s[40:41], s[16:17]
    s_mov_b64 s[44:45], s[18:19]
    s_mov_b32 s16, s15
    s_add_u32 m0, s16, 0
    s_nop 0
    buffer_load_dwordx4 v48, s[44:47], s85 offen lds
    s_add_u32 m0, s88, 0
    s_nop 0
    buffer_load_dwordx4 v44, s[40:43], s84 offen offset:0 lds
    buffer_load_dwordx4 v45, s[40:43], s84 offen offset:1024 lds
    buffer_load_dwordx4 v46, s[40:43], s84 offen offset:2048 lds
    buffer_load_dwordx4 v47, s[40:43], s84 offen offset:3072 lds
    s_add_u32 m0, s16, 4096
    s_add_u32 s85, s85, 172032
    s_add_u32 s84, s84, 128
    s_cmp_eq_u32 s84, s90
    s_cselect_b32 s84, s89, s84
    s_cselect_b32 s85, s91, s85
    buffer_load_dwordx4 v48, s[44:47], s85 offen lds
    s_add_u32 m0, s88, 4096
    s_nop 0
    buffer_load_dwordx4 v44, s[40:43], s84 offen offset:0 lds
    buffer_load_dwordx4 v45, s[40:43], s84 offen offset:1024 lds
    buffer_load_dwordx4 v46, s[40:43], s84 offen offset:2048 lds
    buffer_load_dwordx4 v47, s[40:43], s84 offen offset:3072 lds
    s_lshl_b32 s17, s4, 11
    v_bfe_u32 v11, v1, 2, 2
    v_and_b32 v12, 3, v1
    v_lshlrev_b32_e64 v12, 3, v12
    v_bfe_u32 v13, v1, 4, 1
    v_lshl_add_u32 v12, v13, 5, v12
    v_lshrrev_b32 v13, 5, v1
    v_lshl_add_u32 v5, v13, 3, v11
    v_add_u32 v2, s87, v12
    v_and_b32 v2, 63, v2
    v_lshl_add_u32 v2, v5, 6, v2
    v_add_u32 v55, s16, v2
    v_xor_b32 v56, 1024, v55
    v_xor_b32 v57, 2048, v55
    v_xor_b32 v58, 3072, v55
    v_and_b32 v2, 31, v1
    v_bfe_u32 v3, v1, 1, 3
    v_xor_b32 v3, v3, v13
    s_lshl_b32 s12, s4, 1
    v_xor_b32 v3, s12, v3
    v_lshlrev_b32 v2, 7, v2
    v_add_u32 v2, s88, v2
    v_lshl_add_u32 v51, v3, 4, v2
    v_xor_b32 v52, 32, v51
    v_xor_b32 v53, 64, v51
    v_xor_b32 v54, 96, v51
    v_mov_b32 v14, 0x3f803f80
    v_mov_b32_e64 v67, 0
    v_mov_b32 v68, 0
    v_mov_b32 v69, 0
    v_mov_b32 v70, 0
    v_mov_b32 v71, 0
    v_add_u32 v49, 1792, v50
    s_memrealtime s[98:99]
    s_mov_b32 s80, s36
    s_mov_b32 s81, s37
    s_mov_b32 s82, 256
    s_mov_b32 s83, 0x00020000
    v_lshlrev_b32 v6, 4, v1
    s_or_b32 s12, s2, s4
    v_or_b32 v23, s12, v1
    v_lshlrev_b32_e64 v23, 12, v23
    s_mov_b32 s48, s20
    s_mov_b32 s49, s21
    s_mov_b32 s50, 25088
    s_mov_b32 s51, 0x00020000
    s_mov_b32 s60, s38
    s_mov_b32 s61, s39
    s_mov_b32 s62, 268435456
    s_mov_b32 s63, 0x00020000
    s_add_u32 m0, s16, 8192
    s_add_u32 s85, s85, 172032
    s_add_u32 s84, s84, 128
    s_cmp_eq_u32 s84, s90
    s_cselect_b32 s84, s89, s84
    s_cselect_b32 s85, s91, s85
    buffer_load_dwordx4 v48, s[44:47], s85 offen lds
    s_add_u32 m0, s88, 8192
    s_mov_b32 s52, s22
    s_mov_b32 s53, s23
    s_mov_b32 s54, 401408
    s_mov_b32 s55, 0x00020000
    s_mov_b32 s64, s26
    s_mov_b32 s65, s27
    s_mov_b32 s66, 1605632
    s_mov_b32 s67, 0x00020000
    s_mov_b32 s68, s30
    s_mov_b32 s69, s31
    s_mov_b32 s70, 1605632
    s_mov_b32 s71, 0x00020000
    buffer_load_dwordx4 v44, s[40:43], s84 offen offset:0 lds
    s_mov_b32 s56, s28
    s_mov_b32 s57, s29
    s_mov_b32 s58, 3584
    s_mov_b32 s59, 0x00020000
    s_mov_b32 s72, s32
    s_mov_b32 s73, s33
    s_mov_b32 s74, 896
    s_mov_b32 s75, 0x00020000
    s_mov_b32 s76, s34
    s_mov_b32 s77, s35
    s_mov_b32 s78, 1835008
    s_mov_b32 s79, 0x00020000
    s_waitcnt lgkmcnt(0)
    s_or_b32 s98, s98, 1
    v_mov_b32_e64 v8, s98
    s_mov_b32 s96, 0xf0000000
    s_mov_b32 s97, 0xf0000000
    s_mov_b64 s[0:1], s[38:39]
    buffer_load_dwordx4 v45, s[40:43], s84 offen offset:1024 lds
    v_mov_b32 v86, 0
    v_mov_b32 v87, 0
    v_mov_b32 v90, 0
    v_mov_b32 v91, 0
    v_mov_b32 v94, 0
    v_mov_b32 v95, 0
    v_lshl_add_u32 v5, v13, 2, v11
    v_mul_u32_u24 v59, 56, v5
    v_add_u32_e64 v59, v59, v12
    v_add_u32 v59, 151552, v59
    v_cmp_eq_u32 vcc, 56, v12
    v_add_u32 v2, 2040, v59
    v_bfe_u32 v3, v1, 4, 1
    v_cndmask_b32 v59, v59, v2, vcc
    v_lshl_add_u32 v2, v3, 2, v11
    v_lshl_add_u32 v2, v13, 4, v2
    v_mul_u32_u24 v2, 136, v2
    v_and_b32_e64 v4, 3, v1
    buffer_load_dwordx4 v46, s[40:43], s84 offen offset:2048 lds
    v_lshl_add_u32 v2, v4, 3, v2
    s_lshl_b32 s13, s4, 5
    v_add_u32 v60, s13, v2
    v_and_b32 v2, 15, v1
    v_lshlrev_b32 v2, 4, v2
    v_lshl_add_u32 v2, v3, 9, v2
    v_lshl_add_u32 v61, v13, 10, v2
    v_add_u32 v61, 155648, v61
    v_and_b32_e64 v2, 31, v1
    s_add_u32 s13, s17, 155648
    v_lshl_add_u32 v63, v2, 2, s13
    v_lshl_add_u32 v64, v13, 4, s13
    v_mul_u32_u24 v2, 136, v2
    v_lshl_add_u32 v2, v13, 3, v2
    s_mul_i32 s13, s4, 4352
    v_add_u32_e64 v62, s13, v2
    v_lshlrev_b32 v66, 2, v1
    buffer_load_dwordx4 v47, s[40:43], s84 offen offset:3072 lds
    v_add_u32 v66, 147456, v66
    s_lshl_b32 s13, s4, 8
    v_add_u32 v65, s13, v66
    s_and_b32 s14, s4, 1
    s_lshl_b32 s14, s14, 10
    s_lshr_b32 s13, s4, 1
    s_lshl_b32 s13, s13, 2
    s_add_u32 s14, s14, s13
    s_mul_i32 s13, s5, 1568
    s_add_u32 s14, s14, s13
    s_lshl_b32 s13, s3, 2
    s_add_u32 s13, s13, s4
    s_lshl_b32 s13, s13, 7
    v_lshl_add_u32 v24, v1, 14, s13
    s_mul_i32 s13, s13, 112
    s_and_b32 s15, s2, 1
    s_mul_i32 s15, s15, 1792
    s_add_u32 s13, s13, s15
    v_lshrrev_b32 v2, 4, v1
    v_mul_u32_u24 v2, 3584, v2
    v_and_b32 v3, 15, v1
    v_min_u32 v3, 13, v3
    v_lshl_add_u32 v2, v3, 7, v2
    v_add_u32 v9, s13, v2
    buffer_store_dword v8, v23, s[80:83], 0 offen sc1
    s_lshl_b32 s13, s2, 2
    s_add_u32 s13, s13, s4
    s_lshl_b32 s13, s13, 8
    s_add_u32 s13, s13, 1048576
    v_and_b32 v2, 1, v1
    v_lshlrev_b32 v2, 7, v2
    buffer_load_dword a116, v2, s[60:63], s13 offen sc1
    s_waitcnt vmcnt(12)
    s_barrier
    ds_read_b128 v[96:99], v51 offset:0
    ds_read_b64_tr_b16 v[160:161], v55 offset:0
    ds_read_b64_tr_b16 v[162:163], v55 offset:256
    ds_read_b128 v[100:103], v52 offset:0
    ds_read_b64_tr_b16 v[164:165], v56 offset:0
    ds_read_b64_tr_b16 v[166:167], v56 offset:256
    ds_read_b128 v[104:107], v53 offset:0
    ds_read_b64_tr_b16 v[168:169], v57 offset:0
    ds_read_b64_tr_b16 v[170:171], v57 offset:256
    ds_read_b128 v[108:111], v54 offset:0
    ds_read_b64_tr_b16 v[172:173], v58 offset:0
    ds_read_b64_tr_b16 v[174:175], v58 offset:256
    s_waitcnt vmcnt(7)
    s_barrier
    s_waitcnt lgkmcnt(9)
    v_mfma_f32_32x32x16_bf16 v[192:207], v[160:163], v[96:99], 0
    ds_read_b128 v[112:115], v51 offset:4096
    ds_read_b128 v[116:119], v52 offset:4096
    ds_read_b64_tr_b16 v[176:177], v55 offset:4096
    s_add_u32 m0, s16, 12288
    s_add_u32 s85, s85, 172032
    s_add_u32 s84, s84, 128
    s_cmp_eq_u32 s84, s90
    s_cselect_b32 s84, s89, s84
    s_cselect_b32 s85, s91, s85
    buffer_load_dwordx4 v48, s[44:47], s85 offen lds
    s_add_u32 m0, s88, 12288
    s_waitcnt lgkmcnt(9)
    v_mfma_f32_32x32x16_bf16 v[192:207], v[164:167], v[100:103], v[192:207]
    ds_read_b64_tr_b16 v[178:179], v55 offset:4352
    ds_read_b128 v[120:123], v53 offset:4096
    ds_read_b128 v[124:127], v54 offset:4096
    buffer_load_dwordx4 v44, s[40:43], s84 offen offset:0 lds
    s_waitcnt lgkmcnt(9)
    v_mfma_f32_32x32x16_bf16 v[192:207], v[168:171], v[104:107], v[192:207]
    ds_read_b64_tr_b16 v[180:181], v56 offset:4096
    ds_read_b64_tr_b16 v[182:183], v56 offset:4352
    ds_read_b64_tr_b16 v[184:185], v57 offset:4096
    buffer_load_dwordx4 v45, s[40:43], s84 offen offset:1024 lds
    s_waitcnt lgkmcnt(9)
    v_mfma_f32_32x32x16_bf16 v[192:207], v[172:175], v[108:111], v[192:207]
    ds_read_b64_tr_b16 v[186:187], v57 offset:4352
    ds_read_b64_tr_b16 v[188:189], v58 offset:4096
    ds_read_b64_tr_b16 v[190:191], v58 offset:4352
    buffer_load_dwordx4 v46, s[40:43], s84 offen offset:2048 lds
    ds_read_b128 a[0:3], v51 offset:0
    ds_read_b128 a[4:7], v52 offset:0
    ds_read_b128 a[8:11], v53 offset:0
    ds_read_b128 a[12:15], v54 offset:0
    v_dot2c_f32_bf16 v67, v96, v14
    v_dot2c_f32_bf16 v68, v96, v96
    v_dot2c_f32_bf16 v67, v97, v14
    v_dot2c_f32_bf16 v68, v97, v97
    v_dot2c_f32_bf16 v67, v98, v14
    v_dot2c_f32_bf16 v68, v98, v98
    v_dot2c_f32_bf16 v67, v99, v14
    v_dot2c_f32_bf16 v68, v99, v99
    v_dot2c_f32_bf16 v67, v100, v14
    v_dot2c_f32_bf16 v68, v100, v100
    v_dot2c_f32_bf16 v67, v101, v14
    v_dot2c_f32_bf16 v68, v101, v101
    v_dot2c_f32_bf16 v67, v102, v14
    v_dot2c_f32_bf16 v68, v102, v102
    v_dot2c_f32_bf16 v67, v103, v14
    v_dot2c_f32_bf16 v68, v103, v103
    v_dot2c_f32_bf16 v67, v104, v14
    v_dot2c_f32_bf16 v68, v104, v104
    v_dot2c_f32_bf16 v67, v105, v14
    v_dot2c_f32_bf16 v68, v105, v105
    v_dot2c_f32_bf16 v67, v106, v14
    v_dot2c_f32_bf16 v68, v106, v106
    v_dot2c_f32_bf16 v67, v107, v14
    v_dot2c_f32_bf16 v68, v107, v107
    v_dot2c_f32_bf16 v67, v108, v14
    v_dot2c_f32_bf16 v68, v108, v108
    v_dot2c_f32_bf16 v67, v109, v14
    v_dot2c_f32_bf16 v68, v109, v109
    v_dot2c_f32_bf16 v67, v110, v14
    v_dot2c_f32_bf16 v68, v110, v110
    v_dot2c_f32_bf16 v67, v111, v14
    v_dot2c_f32_bf16 v68, v111, v111
    v_dot2c_f32_bf16 v69, v160, v14
    v_dot2c_f32_bf16 v69, v161, v14
    v_dot2c_f32_bf16 v69, v162, v14
    v_dot2c_f32_bf16 v69, v163, v14
    s_waitcnt lgkmcnt(15)
    v_dot2c_f32_bf16 v67, v112, v14
    v_dot2c_f32_bf16 v68, v112, v112
    v_dot2c_f32_bf16 v67, v113, v14
    v_dot2c_f32_bf16 v68, v113, v113
    v_dot2c_f32_bf16 v67, v114, v14
    v_dot2c_f32_bf16 v68, v114, v114
    v_dot2c_f32_bf16 v67, v115, v14
    v_dot2c_f32_bf16 v68, v115, v115
    s_waitcnt lgkmcnt(14)
    v_dot2c_f32_bf16 v67, v116, v14
    v_dot2c_f32_bf16 v68, v116, v116
    v_dot2c_f32_bf16 v67, v117, v14
    v_dot2c_f32_bf16 v68, v117, v117
    v_dot2c_f32_bf16 v67, v118, v14
    v_dot2c_f32_bf16 v68, v118, v118
    v_dot2c_f32_bf16 v67, v119, v14
    v_dot2c_f32_bf16 v68, v119, v119
    s_waitcnt lgkmcnt(11)
    v_dot2c_f32_bf16 v67, v120, v14
    v_dot2c_f32_bf16 v68, v120, v120
    v_dot2c_f32_bf16 v67, v121, v14
    v_dot2c_f32_bf16 v68, v121, v121
    v_dot2c_f32_bf16 v67, v122, v14
    v_dot2c_f32_bf16 v68, v122, v122
    v_dot2c_f32_bf16 v67, v123, v14
    v_dot2c_f32_bf16 v68, v123, v123
    s_waitcnt lgkmcnt(10)
    v_dot2c_f32_bf16 v67, v124, v14
    v_dot2c_f32_bf16 v68, v124, v124
    v_dot2c_f32_bf16 v67, v125, v14
    v_dot2c_f32_bf16 v68, v125, v125
    v_dot2c_f32_bf16 v67, v126, v14
    v_dot2c_f32_bf16 v68, v126, v126
    v_dot2c_f32_bf16 v67, v127, v14
    v_dot2c_f32_bf16 v68, v127, v127
    v_dot2c_f32_bf16 v69, v176, v14
    v_dot2c_f32_bf16 v69, v177, v14
    v_dot2c_f32_bf16 v69, v178, v14
    v_dot2c_f32_bf16 v69, v179, v14
    buffer_load_dwordx4 v47, s[40:43], s84 offen offset:3072 lds
    s_waitcnt vmcnt(7) lgkmcnt(0)
    s_barrier
    v_mfma_f32_32x32x16_bf16 v[192:207], v[176:179], v[112:115], v[192:207]
    ds_read_b128 v[128:131], v51 offset:8192
    ds_read_b128 v[132:135], v52 offset:8192
    ds_read_b64_tr_b16 v[160:161], v55 offset:8192
    s_add_u32 m0, s16, 16384
    s_add_u32 s85, s85, 172032
    s_add_u32 s84, s84, 128
    s_cmp_eq_u32 s84, s90
    s_cselect_b32 s84, s89, s84
    s_cselect_b32 s85, s91, s85
    buffer_load_dwordx4 v48, s[44:47], s85 offen lds
    s_add_u32 m0, s88, 0
    v_mfma_f32_32x32x16_bf16 v[192:207], v[180:183], v[116:119], v[192:207]
    ds_read_b64_tr_b16 v[162:163], v55 offset:8448
    ds_read_b128 v[136:139], v53 offset:8192
    ds_read_b128 v[140:143], v54 offset:8192
    buffer_load_dwordx4 v44, s[40:43], s84 offen offset:0 lds
    v_mfma_f32_32x32x16_bf16 v[192:207], v[184:187], v[120:123], v[192:207]
    ds_read_b64_tr_b16 v[164:165], v56 offset:8192
    ds_read_b64_tr_b16 v[166:167], v56 offset:8448
    ds_read_b64_tr_b16 v[168:169], v57 offset:8192
    buffer_load_dwordx4 v45, s[40:43], s84 offen offset:1024 lds
    v_mfma_f32_32x32x16_bf16 v[192:207], v[188:191], v[124:127], v[192:207]
    ds_read_b64_tr_b16 v[170:171], v57 offset:8448
    ds_read_b64_tr_b16 v[172:173], v58 offset:8192
    ds_read_b64_tr_b16 v[174:175], v58 offset:8448
    buffer_load_dwordx4 v46, s[40:43], s84 offen offset:2048 lds
    ds_read_b128 a[16:19], v51 offset:4096
    ds_read_b128 a[20:23], v52 offset:4096
    ds_read_b128 a[24:27], v53 offset:4096
    ds_read_b128 a[28:31], v54 offset:4096
    s_waitcnt lgkmcnt(15)
    v_dot2c_f32_bf16 v67, v128, v14
    v_dot2c_f32_bf16 v68, v128, v128
    v_dot2c_f32_bf16 v67, v129, v14
    v_dot2c_f32_bf16 v68, v129, v129
    v_dot2c_f32_bf16 v67, v130, v14
    v_dot2c_f32_bf16 v68, v130, v130
    v_dot2c_f32_bf16 v67, v131, v14
    v_dot2c_f32_bf16 v68, v131, v131
    s_waitcnt lgkmcnt(14)
    v_dot2c_f32_bf16 v67, v132, v14
    v_dot2c_f32_bf16 v68, v132, v132
    v_dot2c_f32_bf16 v67, v133, v14
    v_dot2c_f32_bf16 v68, v133, v133
    v_dot2c_f32_bf16 v67, v134, v14
    v_dot2c_f32_bf16 v68, v134, v134
    v_dot2c_f32_bf16 v67, v135, v14
    v_dot2c_f32_bf16 v68, v135, v135
    s_waitcnt lgkmcnt(11)
    v_dot2c_f32_bf16 v67, v136, v14
    v_dot2c_f32_bf16 v68, v136, v136
    v_dot2c_f32_bf16 v67, v137, v14
    v_dot2c_f32_bf16 v68, v137, v137
    v_dot2c_f32_bf16 v67, v138, v14
    v_dot2c_f32_bf16 v68, v138, v138
    v_dot2c_f32_bf16 v67, v139, v14
    v_dot2c_f32_bf16 v68, v139, v139
    s_waitcnt lgkmcnt(10)
    v_dot2c_f32_bf16 v67, v140, v14
    v_dot2c_f32_bf16 v68, v140, v140
    v_dot2c_f32_bf16 v67, v141, v14
    v_dot2c_f32_bf16 v68, v141, v141
    v_dot2c_f32_bf16 v67, v142, v14
    v_dot2c_f32_bf16 v68, v142, v142
    v_dot2c_f32_bf16 v67, v143, v14
    v_dot2c_f32_bf16 v68, v143, v143
    v_dot2c_f32_bf16 v69, v160, v14
    v_dot2c_f32_bf16 v69, v161, v14
    v_dot2c_f32_bf16 v69, v162, v14
    v_dot2c_f32_bf16 v69, v163, v14
    buffer_load_dwordx4 v47, s[40:43], s84 offen offset:3072 lds
    s_waitcnt vmcnt(5) lgkmcnt(0)
    s_barrier
    v_mfma_f32_32x32x16_bf16 v[192:207], v[160:163], v[128:131], v[192:207]
    ds_read_b128 v[144:147], v51 offset:12288
    ds_read_b128 v[148:151], v52 offset:12288
    ds_read_b64_tr_b16 v[176:177], v55 offset:12288
    s_add_u32 m0, s16, 20480
    s_add_u32 s85, s85, 172032
    s_add_u32 s84, s84, 128
    s_cmp_eq_u32 s84, s90
    s_cselect_b32 s84, s89, s84
    s_cselect_b32 s85, s91, s85
    buffer_load_dwordx4 v48, s[44:47], s85 offen lds
    s_add_u32 m0, s88, 4096
    v_mfma_f32_32x32x16_bf16 v[192:207], v[164:167], v[132:135], v[192:207]
    ds_read_b64_tr_b16 v[178:179], v55 offset:12544
    ds_read_b128 v[152:155], v53 offset:12288
    ds_read_b128 v[156:159], v54 offset:12288
    buffer_load_dwordx4 v44, s[40:43], s84 offen offset:0 lds
    v_mfma_f32_32x32x16_bf16 v[192:207], v[168:171], v[136:139], v[192:207]
    ds_read_b64_tr_b16 v[180:181], v56 offset:12288
    ds_read_b64_tr_b16 v[182:183], v56 offset:12544
    ds_read_b64_tr_b16 v[184:185], v57 offset:12288
    buffer_load_dwordx4 v45, s[40:43], s84 offen offset:1024 lds
    v_mfma_f32_32x32x16_bf16 v[192:207], v[172:175], v[140:143], v[192:207]
    ds_read_b64_tr_b16 v[186:187], v57 offset:12544
    ds_read_b64_tr_b16 v[188:189], v58 offset:12288
    ds_read_b64_tr_b16 v[190:191], v58 offset:12544
    buffer_load_dwordx4 v46, s[40:43], s84 offen offset:2048 lds
    ds_read_b128 a[32:35], v51 offset:8192
    ds_read_b128 a[36:39], v52 offset:8192
    ds_read_b128 a[40:43], v53 offset:8192
    ds_read_b128 a[44:47], v54 offset:8192
    s_waitcnt lgkmcnt(15)
    v_dot2c_f32_bf16 v67, v144, v14
    v_dot2c_f32_bf16 v68, v144, v144
    v_dot2c_f32_bf16 v67, v145, v14
    v_dot2c_f32_bf16 v68, v145, v145
    v_dot2c_f32_bf16 v67, v146, v14
    v_dot2c_f32_bf16 v68, v146, v146
    v_dot2c_f32_bf16 v67, v147, v14
    v_dot2c_f32_bf16 v68, v147, v147
    s_waitcnt lgkmcnt(14)
    v_dot2c_f32_bf16 v67, v148, v14
    v_dot2c_f32_bf16 v68, v148, v148
    v_dot2c_f32_bf16 v67, v149, v14
    v_dot2c_f32_bf16 v68, v149, v149
    v_dot2c_f32_bf16 v67, v150, v14
    v_dot2c_f32_bf16 v68, v150, v150
    v_dot2c_f32_bf16 v67, v151, v14
    v_dot2c_f32_bf16 v68, v151, v151
    s_waitcnt lgkmcnt(11)
    v_dot2c_f32_bf16 v67, v152, v14
    v_dot2c_f32_bf16 v68, v152, v152
    v_dot2c_f32_bf16 v67, v153, v14
    v_dot2c_f32_bf16 v68, v153, v153
    v_dot2c_f32_bf16 v67, v154, v14
    v_dot2c_f32_bf16 v68, v154, v154
    v_dot2c_f32_bf16 v67, v155, v14
    v_dot2c_f32_bf16 v68, v155, v155
    s_waitcnt lgkmcnt(10)
    v_dot2c_f32_bf16 v67, v156, v14
    v_dot2c_f32_bf16 v68, v156, v156
    v_dot2c_f32_bf16 v67, v157, v14
    v_dot2c_f32_bf16 v68, v157, v157
    v_dot2c_f32_bf16 v67, v158, v14
    v_dot2c_f32_bf16 v68, v158, v158
    v_dot2c_f32_bf16 v67, v159, v14
    v_dot2c_f32_bf16 v68, v159, v159
    v_dot2c_f32_bf16 v69, v176, v14
    v_dot2c_f32_bf16 v69, v177, v14
    v_dot2c_f32_bf16 v69, v178, v14
    v_dot2c_f32_bf16 v69, v179, v14
    buffer_load_dwordx4 v47, s[40:43], s84 offen offset:3072 lds
    s_waitcnt vmcnt(5) lgkmcnt(0)
    s_barrier
    v_mfma_f32_32x32x16_bf16 v[192:207], v[176:179], v[144:147], v[192:207]
    ds_read_b128 v[96:99], v51 offset:0
    ds_read_b128 v[100:103], v52 offset:0
    ds_read_b64_tr_b16 v[160:161], v55 offset:16384
    s_add_u32 m0, s16, 24576
    s_add_u32 s85, s85, 172032
    s_add_u32 s84, s84, 128
    s_cmp_eq_u32 s84, s90
    s_cselect_b32 s84, s89, s84
    s_cselect_b32 s85, s91, s85
    buffer_load_dwordx4 v48, s[44:47], s85 offen lds
    s_add_u32 m0, s88, 8192
    v_mfma_f32_32x32x16_bf16 v[192:207], v[180:183], v[148:151], v[192:207]
    ds_read_b64_tr_b16 v[162:163], v55 offset:16640
    ds_read_b128 v[104:107], v53 offset:0
    ds_read_b128 v[108:111], v54 offset:0
    buffer_load_dwordx4 v44, s[40:43], s84 offen offset:0 lds
    v_mfma_f32_32x32x16_bf16 v[192:207], v[184:187], v[152:155], v[192:207]
    ds_read_b64_tr_b16 v[164:165], v56 offset:16384
    ds_read_b64_tr_b16 v[166:167], v56 offset:16640
    ds_read_b64_tr_b16 v[168:169], v57 offset:16384
    buffer_load_dwordx4 v45, s[40:43], s84 offen offset:1024 lds
    v_mfma_f32_32x32x16_bf16 v[192:207], v[188:191], v[156:159], v[192:207]
    ds_read_b64_tr_b16 v[170:171], v57 offset:16640
    ds_read_b64_tr_b16 v[172:173], v58 offset:16384
    ds_read_b64_tr_b16 v[174:175], v58 offset:16640
    buffer_load_dwordx4 v46, s[40:43], s84 offen offset:2048 lds
    s_waitcnt lgkmcnt(11)
    v_dot2c_f32_bf16 v67, v96, v14
    v_dot2c_f32_bf16 v68, v96, v96
    v_dot2c_f32_bf16 v67, v97, v14
    v_dot2c_f32_bf16 v68, v97, v97
    v_dot2c_f32_bf16 v67, v98, v14
    v_dot2c_f32_bf16 v68, v98, v98
    v_dot2c_f32_bf16 v67, v99, v14
    v_dot2c_f32_bf16 v68, v99, v99
    s_waitcnt lgkmcnt(10)
    v_dot2c_f32_bf16 v67, v100, v14
    v_dot2c_f32_bf16 v68, v100, v100
    v_dot2c_f32_bf16 v67, v101, v14
    v_dot2c_f32_bf16 v68, v101, v101
    v_dot2c_f32_bf16 v67, v102, v14
    v_dot2c_f32_bf16 v68, v102, v102
    v_dot2c_f32_bf16 v67, v103, v14
    v_dot2c_f32_bf16 v68, v103, v103
    s_waitcnt lgkmcnt(7)
    v_dot2c_f32_bf16 v67, v104, v14
    v_dot2c_f32_bf16 v68, v104, v104
    v_dot2c_f32_bf16 v67, v105, v14
    v_dot2c_f32_bf16 v68, v105, v105
    v_dot2c_f32_bf16 v67, v106, v14
    v_dot2c_f32_bf16 v68, v106, v106
    v_dot2c_f32_bf16 v67, v107, v14
    v_dot2c_f32_bf16 v68, v107, v107
    s_waitcnt lgkmcnt(6)
    v_dot2c_f32_bf16 v67, v108, v14
    v_dot2c_f32_bf16 v68, v108, v108
    v_dot2c_f32_bf16 v67, v109, v14
    v_dot2c_f32_bf16 v68, v109, v109
    v_dot2c_f32_bf16 v67, v110, v14
    v_dot2c_f32_bf16 v68, v110, v110
    v_dot2c_f32_bf16 v67, v111, v14
    v_dot2c_f32_bf16 v68, v111, v111
    v_dot2c_f32_bf16 v69, v160, v14
    v_dot2c_f32_bf16 v69, v161, v14
    v_dot2c_f32_bf16 v69, v162, v14
    v_dot2c_f32_bf16 v69, v163, v14
    buffer_load_dwordx4 v47, s[40:43], s84 offen offset:3072 lds
    s_add_u32 m0, s16, 151552
    s_nop 0
    buffer_load_dwordx4 v6, s[48:51], s14 offen lds
    s_add_u32 m0, s16, 28672
    s_nop 0
    buffer_load_dwordx4 v49, s[44:47], s93 offen lds
    s_waitcnt vmcnt(7) lgkmcnt(0)
    s_barrier
    v_mfma_f32_32x32x16_bf16 v[192:207], v[160:163], v[96:99], v[192:207]
    ds_read_b128 v[112:115], v51 offset:4096
    ds_read_b128 v[116:119], v52 offset:4096
    ds_read_b64_tr_b16 v[176:177], v55 offset:20480
    s_add_u32 m0, s16, 32768
    s_add_u32 s93, s93, 172032
    s_cmp_eq_u32 s93, s94
    s_cselect_b32 s93, s91, s93
    buffer_load_dwordx4 v49, s[44:47], s93 offen lds
    v_mfma_f32_32x32x16_bf16 v[192:207], v[164:167], v[100:103], v[192:207]
    ds_read_b64_tr_b16 v[178:179], v55 offset:20736
    ds_read_b128 v[120:123], v53 offset:4096
    ds_read_b128 v[124:127], v54 offset:4096
    s_add_u32 m0, s16, 36864
    s_add_u32 s93, s93, 172032
    s_cmp_eq_u32 s93, s94
    s_cselect_b32 s93, s91, s93
    buffer_load_dwordx4 v49, s[44:47], s93 offen lds
    v_mfma_f32_32x32x16_bf16 v[192:207], v[168:171], v[104:107], v[192:207]
    ds_read_b64_tr_b16 v[180:181], v56 offset:20480
    ds_read_b64_tr_b16 v[182:183], v56 offset:20736
    ds_read_b64_tr_b16 v[184:185], v57 offset:20480
    s_add_u32 m0, s16, 40960
    s_add_u32 s93, s93, 172032
    s_cmp_eq_u32 s93, s94
    s_cselect_b32 s93, s91, s93
    buffer_load_dwordx4 v49, s[44:47], s93 offen lds
    v_mfma_f32_32x32x16_bf16 v[192:207], v[172:175], v[108:111], v[192:207]
    ds_read_b64_tr_b16 v[186:187], v57 offset:20736
    ds_read_b64_tr_b16 v[188:189], v58 offset:20480
    ds_read_b64_tr_b16 v[190:191], v58 offset:20736
    s_add_u32 m0, s16, 45056
    s_add_u32 s93, s93, 172032
    s_cmp_eq_u32 s93, s94
    s_cselect_b32 s93, s91, s93
    buffer_load_dwordx4 v49, s[44:47], s93 offen lds
    s_waitcnt lgkmcnt(11)
    v_dot2c_f32_bf16 v67, v112, v14
    v_dot2c_f32_bf16 v68, v112, v112
    v_dot2c_f32_bf16 v67, v113, v14
    v_dot2c_f32_bf16 v68, v113, v113
    v_dot2c_f32_bf16 v67, v114, v14
    v_dot2c_f32_bf16 v68, v114, v114
    v_dot2c_f32_bf16 v67, v115, v14
    v_dot2c_f32_bf16 v68, v115, v115
    s_waitcnt lgkmcnt(10)
    v_dot2c_f32_bf16 v67, v116, v14
    v_dot2c_f32_bf16 v68, v116, v116
    v_dot2c_f32_bf16 v67, v117, v14
    v_dot2c_f32_bf16 v68, v117, v117
    v_dot2c_f32_bf16 v67, v118, v14
    v_dot2c_f32_bf16 v68, v118, v118
    v_dot2c_f32_bf16 v67, v119, v14
    v_dot2c_f32_bf16 v68, v119, v119
    s_waitcnt lgkmcnt(7)
    v_dot2c_f32_bf16 v67, v120, v14
    v_dot2c_f32_bf16 v68, v120, v120
    v_dot2c_f32_bf16 v67, v121, v14
    v_dot2c_f32_bf16 v68, v121, v121
    v_dot2c_f32_bf16 v67, v122, v14
    v_dot2c_f32_bf16 v68, v122, v122
    v_dot2c_f32_bf16 v67, v123, v14
    v_dot2c_f32_bf16 v68, v123, v123
    s_waitcnt lgkmcnt(6)
    v_dot2c_f32_bf16 v67, v124, v14
    v_dot2c_f32_bf16 v68, v124, v124
    v_dot2c_f32_bf16 v67, v125, v14
    v_dot2c_f32_bf16 v68, v125, v125
    v_dot2c_f32_bf16 v67, v126, v14
    v_dot2c_f32_bf16 v68, v126, v126
    v_dot2c_f32_bf16 v67, v127, v14
    v_dot2c_f32_bf16 v68, v127, v127
    v_dot2c_f32_bf16 v69, v176, v14
    v_dot2c_f32_bf16 v69, v177, v14
    v_dot2c_f32_bf16 v69, v178, v14
    v_dot2c_f32_bf16 v69, v179, v14
    s_add_u32 m0, s16, 49152
    s_add_u32 s93, s93, 172032
    s_cmp_eq_u32 s93, s94
    s_cselect_b32 s93, s91, s93
    buffer_load_dwordx4 v49, s[44:47], s93 offen lds
    s_add_u32 m0, s16, 53248
    s_add_u32 s93, s93, 172032
    s_cmp_eq_u32 s93, s94
    s_cselect_b32 s93, s91, s93
    buffer_load_dwordx4 v49, s[44:47], s93 offen lds
    s_waitcnt vmcnt(8) lgkmcnt(0)
    s_barrier
    v_mfma_f32_32x32x16_bf16 v[192:207], v[176:179], v[112:115], v[192:207]
    ds_read_b128 v[128:131], v51 offset:8192
    ds_read_b128 v[132:135], v52 offset:8192
    ds_read_b64_tr_b16 v[160:161], v55 offset:24576
    v_mov_b32_e64 v2, 0
    buffer_load_dword v7, v2, s[80:83], 0 offen sc1
    v_mfma_f32_32x32x16_bf16 v[192:207], v[180:183], v[116:119], v[192:207]
    ds_read_b64_tr_b16 v[162:163], v55 offset:24832
    ds_read_b128 v[136:139], v53 offset:8192
    ds_read_b128 v[140:143], v54 offset:8192
    s_add_u32 m0, s16, 57344
    s_add_u32 s93, s93, 172032
    s_cmp_eq_u32 s93, s94
    s_cselect_b32 s93, s91, s93
    buffer_load_dwordx4 v50, s[44:47], s93 offen lds
    v_mfma_f32_32x32x16_bf16 v[192:207], v[184:187], v[120:123], v[192:207]
    ds_read_b64_tr_b16 v[164:165], v56 offset:24576
    ds_read_b64_tr_b16 v[166:167], v56 offset:24832
    ds_read_b64_tr_b16 v[168:169], v57 offset:24576
    s_add_u32 m0, s16, 61440
    s_add_u32 s93, s93, 172032
    s_cmp_eq_u32 s93, s94
    s_cselect_b32 s93, s91, s93
    buffer_load_dwordx4 v50, s[44:47], s93 offen lds
    v_mfma_f32_32x32x16_bf16 v[192:207], v[188:191], v[124:127], v[192:207]
    ds_read_b64_tr_b16 v[170:171], v57 offset:24832
    ds_read_b64_tr_b16 v[172:173], v58 offset:24576
    ds_read_b64_tr_b16 v[174:175], v58 offset:24832
    s_add_u32 m0, s16, 65536
    s_add_u32 s93, s93, 172032
    s_cmp_eq_u32 s93, s94
    s_cselect_b32 s93, s91, s93
    buffer_load_dwordx4 v50, s[44:47], s93 offen lds
    s_waitcnt lgkmcnt(11)
    v_dot2c_f32_bf16 v67, v128, v14
    v_dot2c_f32_bf16 v68, v128, v128
    v_dot2c_f32_bf16 v67, v129, v14
    v_dot2c_f32_bf16 v68, v129, v129
    v_dot2c_f32_bf16 v67, v130, v14
    v_dot2c_f32_bf16 v68, v130, v130
    v_dot2c_f32_bf16 v67, v131, v14
    v_dot2c_f32_bf16 v68, v131, v131
    s_waitcnt lgkmcnt(10)
    v_dot2c_f32_bf16 v67, v132, v14
    v_dot2c_f32_bf16 v68, v132, v132
    v_dot2c_f32_bf16 v67, v133, v14
    v_dot2c_f32_bf16 v68, v133, v133
    v_dot2c_f32_bf16 v67, v134, v14
    v_dot2c_f32_bf16 v68, v134, v134
    v_dot2c_f32_bf16 v67, v135, v14
    v_dot2c_f32_bf16 v68, v135, v135
    s_waitcnt lgkmcnt(7)
    v_dot2c_f32_bf16 v67, v136, v14
    v_dot2c_f32_bf16 v68, v136, v136
    v_dot2c_f32_bf16 v67, v137, v14
    v_dot2c_f32_bf16 v68, v137, v137
    v_dot2c_f32_bf16 v67, v138, v14
    v_dot2c_f32_bf16 v68, v138, v138
    v_dot2c_f32_bf16 v67, v139, v14
    v_dot2c_f32_bf16 v68, v139, v139
    s_waitcnt lgkmcnt(6)
    v_dot2c_f32_bf16 v67, v140, v14
    v_dot2c_f32_bf16 v68, v140, v140
    v_dot2c_f32_bf16 v67, v141, v14
    v_dot2c_f32_bf16 v68, v141, v141
    v_dot2c_f32_bf16 v67, v142, v14
    v_dot2c_f32_bf16 v68, v142, v142
    v_dot2c_f32_bf16 v67, v143, v14
    v_dot2c_f32_bf16 v68, v143, v143
    v_dot2c_f32_bf16 v69, v160, v14
    v_dot2c_f32_bf16 v69, v161, v14
    v_dot2c_f32_bf16 v69, v162, v14
    v_dot2c_f32_bf16 v69, v163, v14
    s_nop 2
    ds_write_b32 v65, v69
    s_waitcnt vmcnt(11) lgkmcnt(0)
    s_barrier
    v_mfma_f32_32x32x16_bf16 v[192:207], v[160:163], v[128:131], v[192:207]
    ds_read_b32 v76, v66 offset:0
    ds_read_b32 v77, v66 offset:256
    ds_read_b32 v78, v66 offset:512
    ds_read_b32 v79, v66 offset:768
    ds_read_b64_tr_b16 a[48:49], v59 offset:0
    ds_read_b64_tr_b16 a[50:51], v59 offset:448
    ds_read_b64_tr_b16 a[52:53], v59 offset:896
    v_mfma_f32_32x32x16_bf16 v[192:207], v[164:167], v[132:135], v[192:207]
    ds_read_b64_tr_b16 a[54:55], v59 offset:1344
    v_mov_b32 v2, v67
    s_nop 1
    v_permlane32_swap_b32_e64 v67, v2
    v_add_f32 v67, v67, v2
    v_mul_f32 v67, 0xbb124925, v67
    v_cvt_pk_bf16_f32 v84, v67, v67
    v_mfma_f32_32x32x16_bf16 v[192:207], v[168:171], v[136:139], v[192:207]
    v_and_b32 v2, 0xffff0000, v84
    v_sub_f32 v2, v67, v2
    v_cvt_pk_bf16_f32 v85, v2, v2
    s_waitcnt lgkmcnt(6)
    v_add_f32 v76, v76, v77
    s_waitcnt lgkmcnt(4)
    v_add_f32 v78, v78, v79
    v_add_f32 v76, v76, v78
    v_cvt_pk_bf16_f32 v3, v76, v76
    v_mfma_f32_32x32x16_bf16 v[192:207], v[172:175], v[140:143], v[192:207]
    v_and_b32 v3, 0xffff0000, v3
    v_sub_f32 v3, v76, v3
    v_cvt_pk_bf16_f32 v88, v76, v3
    v_mov_b32 v89, v88
    s_nop 1
    v_mfma_f32_32x32x16_bf16 v[192:207], v[88:91], v[84:87], v[192:207]
    v_mov_b32 v3, v68
    s_nop 1
    v_permlane32_swap_b32 v68, v3
    v_add_f32_e64 v68, v68, v3
    v_mul_f32 v5, 0x3b124925, v68
    v_fma_f32 v5, -v67, v67, v5
    s_mov_b32 exec_lo, 0
    s_mov_b32 exec_hi, -1
    s_waitcnt lgkmcnt(0)
    v_accvgpr_write_b32 a54, 0
    v_accvgpr_write_b32 a55, 0
    s_mov_b64 exec, -1
    v_cvt_pk_bf16_f32 v28, v192, v193
    v_cvt_pk_bf16_f32 v29, v194, v195
    v_cvt_pk_bf16_f32 v30, v196, v197
    v_cvt_pk_bf16_f32 v31, v198, v199
    v_cvt_pk_bf16_f32 v32, v200, v201
    v_cvt_pk_bf16_f32 v33, v202, v203
    v_cvt_pk_bf16_f32 v34, v204, v205
    v_cvt_pk_bf16_f32 v35, v206, v207
    v_mfma_f32_32x32x16_bf16 v[192:207], a[48:51], v[28:31], 0
    v_max_f32 v5, 0, v5
    v_add_f32 v5, 0x3727c5ac, v5
    v_rsq_f32 v72, v5
    v_mfma_f32_32x32x16_bf16 v[192:207], a[52:55], v[32:35], v[192:207]
    s_add_u32 m0, s16, 69632
    s_add_u32 s93, s93, 172032
    s_cmp_eq_u32 s93, s94
    s_cselect_b32 s93, s91, s93
    buffer_load_dwordx4 v50, s[44:47], s93 offen lds
    s_add_u32 m0, s16, 73728
    s_add_u32 s93, s93, 172032
    s_cmp_eq_u32 s93, s94
    s_cselect_b32 s93, s91, s93
    buffer_load_dwordx4 v50, s[44:47], s93 offen lds
    v_mul_f32 v74, 0x3fb8aa3b, v72
    ds_write_b32 v63, v72
    v_max3_f32 v76, v192, v193, v194
    v_min3_f32 v77, v192, v193, v194
    v_max3_f32 v76, v76, v195, v196
    v_min3_f32 v77, v77, v195, v196
    v_max3_f32 v76, v76, v197, v198
    v_min3_f32 v77, v77, v197, v198
    v_max3_f32 v76, v76, v199, v200
    v_min3_f32 v77, v77, v199, v200
    v_max3_f32 v76, v76, v201, v202
    v_min3_f32 v77, v77, v201, v202
    v_max3_f32 v76, v76, v203, v204
    v_min3_f32 v77, v77, v203, v204
    v_max_f32_e64 v76, v76, v205
    v_max_f32 v77, -v77, -v205
    v_mov_b32 v35, 0
    v_mov_b32 v43, 0
    v_permlane32_swap_b32 v76, v77
    v_max_f32 v76, v76, v77
    v_mul_f32 v78, v76, v74
    v_mul_f32 v80, v76, v74
    s_add_u32 m0, s16, 77824
    s_add_u32 s93, s93, 172032
    s_cmp_eq_u32 s93, s94
    s_cselect_b32 s93, s91, s93
    buffer_load_dwordx4 v50, s[44:47], s93 offen lds
    s_add_u32 m0, s16, 81920
    s_add_u32 s93, s93, 172032
    s_cmp_eq_u32 s93, s94
    s_cselect_b32 s93, s91, s93
    buffer_load_dwordx4 v50, s[44:47], s93 offen lds
    v_permlane32_swap_b32 v78, v80
    s_waitcnt vmcnt(8)
    ds_read_b64_tr_b16 v[160:161], v55 offset:28672
    ds_read_b64_tr_b16 v[162:163], v55 offset:28928
    ds_read_b64_tr_b16 v[164:165], v55 offset:32768
    ds_read_b64_tr_b16 v[166:167], v55 offset:33024
    ds_read_b64_tr_b16 v[168:169], v55 offset:36864
    ds_read_b64_tr_b16 v[170:171], v55 offset:37120
    ds_read_b64_tr_b16 v[172:173], v55 offset:40960
    ds_read_b64_tr_b16 v[174:175], v55 offset:41216
    ds_read_b64_tr_b16 v[176:177], v55 offset:45056
    ds_read_b64_tr_b16 v[178:179], v55 offset:45312
    ds_read_b64_tr_b16 v[180:181], v55 offset:49152
    ds_read_b64_tr_b16 v[182:183], v55 offset:49408
    v_pk_fma_f32 v[224:225], v[192:193], v[74:75], v[78:79] op_sel_hi:[1,0,0] neg_lo:[0,0,1] neg_hi:[0,0,1]
    v_pk_fma_f32 v[238:239], v[192:193], v[74:75], v[80:81] op_sel_hi:[1,0,0] neg_lo:[1,0,1] neg_hi:[1,0,1]
    v_pk_fma_f32 v[226:227], v[194:195], v[74:75], v[78:79] op_sel_hi:[1,0,0] neg_lo:[0,0,1] neg_hi:[0,0,1]
    v_pk_fma_f32 v[240:241], v[194:195], v[74:75], v[80:81] op_sel_hi:[1,0,0] neg_lo:[1,0,1] neg_hi:[1,0,1]
    v_pk_fma_f32 v[228:229], v[196:197], v[74:75], v[78:79] op_sel_hi:[1,0,0] neg_lo:[0,0,1] neg_hi:[0,0,1]
    v_pk_fma_f32 v[242:243], v[196:197], v[74:75], v[80:81] op_sel_hi:[1,0,0] neg_lo:[1,0,1] neg_hi:[1,0,1]
    v_pk_fma_f32 v[230:231], v[198:199], v[74:75], v[78:79] op_sel_hi:[1,0,0] neg_lo:[0,0,1] neg_hi:[0,0,1]
    v_pk_fma_f32 v[244:245], v[198:199], v[74:75], v[80:81] op_sel_hi:[1,0,0] neg_lo:[1,0,1] neg_hi:[1,0,1]
    v_pk_fma_f32 v[232:233], v[200:201], v[74:75], v[78:79] op_sel_hi:[1,0,0] neg_lo:[0,0,1] neg_hi:[0,0,1]
    v_pk_fma_f32 v[246:247], v[200:201], v[74:75], v[80:81] op_sel_hi:[1,0,0] neg_lo:[1,0,1] neg_hi:[1,0,1]
    v_pk_fma_f32 v[234:235], v[202:203], v[74:75], v[78:79] op_sel_hi:[1,0,0] neg_lo:[0,0,1] neg_hi:[0,0,1]
    v_pk_fma_f32 v[248:249], v[202:203], v[74:75], v[80:81] op_sel_hi:[1,0,0] neg_lo:[1,0,1] neg_hi:[1,0,1]
    v_pk_fma_f32 v[236:237], v[204:205], v[74:75], v[78:79] op_sel_hi:[1,0,0] neg_lo:[0,0,1] neg_hi:[0,0,1]
    v_pk_fma_f32 v[250:251], v[204:205], v[74:75], v[80:81] op_sel_hi:[1,0,0] neg_lo:[1,0,1] neg_hi:[1,0,1]
    s_mov_b32 s92, 0
    buffer_load_dword a116, v24, s[52:55], s92 offen
    buffer_load_dword a116, v9, s[64:67], 0 offen
    s_barrier
    s_waitcnt lgkmcnt(8)
    v_mfma_f32_32x32x16_bf16 v[208:223], a[0:3], v[160:163], 0
    ds_read_b64_tr_b16 v[184:185], v55 offset:53248
    ds_read_b64_tr_b16 v[186:187], v55 offset:53504
    v_exp_f32 v224, v224
    v_exp_f32_e64 v225, v225
    v_mfma_f32_32x32x16_bf16 v[208:223], a[16:19], v[164:167], v[208:223]
    ds_read_b64_tr_b16 a[92:93], v56 offset:28672
    ds_read_b64_tr_b16 a[94:95], v56 offset:28928
    v_exp_f32_e64 v226, v226
    v_exp_f32 v227, v227
    s_waitcnt lgkmcnt(8)
    v_mfma_f32_32x32x16_bf16 v[208:223], a[32:35], v[168:171], v[208:223]
    ds_read_b64_tr_b16 a[64:65], v57 offset:28672
    ds_read_b64_tr_b16 a[66:67], v57 offset:28928
    v_exp_f32 v228, v228
    v_exp_f32 v229, v229
    v_mfma_f32_32x32x16_bf16 v[208:223], v[144:147], v[172:175], v[208:223]
    ds_read_b64_tr_b16 a[68:69], v58 offset:28672
    ds_read_b64_tr_b16 a[70:71], v58 offset:28928
    v_exp_f32 v230, v230
    v_exp_f32_e64 v231, v231
    s_waitcnt lgkmcnt(8)
    v_mfma_f32_32x32x16_bf16 v[208:223], v[96:99], v[176:179], v[208:223]
    ds_read_b64_tr_b16 a[72:73], v56 offset:32768
    ds_read_b64_tr_b16 a[74:75], v56 offset:33024
    v_exp_f32 v232, v232
    v_exp_f32 v233, v233
    v_mfma_f32_32x32x16_bf16 v[208:223], v[112:115], v[180:183], v[208:223]
    ds_read_b64_tr_b16 a[76:77], v57 offset:32768
    ds_read_b64_tr_b16 a[78:79], v57 offset:33024
    v_exp_f32_e64 v234, v234
    v_exp_f32 v235, v235
    s_waitcnt lgkmcnt(8)
    v_mfma_f32_32x32x16_bf16 v[208:223], v[128:131], v[184:187], v[208:223]
    ds_read_b64_tr_b16 a[80:81], v58 offset:32768
    ds_read_b64_tr_b16 a[82:83], v58 offset:33024
    v_exp_f32 v236, v236
    v_exp_f32 v237, v237
    v_mfma_f32_32x32x16_bf16 v[208:223], a[4:7], a[92:95], v[208:223]
    ds_read_b64_tr_b16 a[84:85], v56 offset:36864
    ds_read_b64_tr_b16 a[86:87], v56 offset:37120
    v_exp_f32 v238, v238
    v_exp_f32_e64 v239, v239
    s_waitcnt lgkmcnt(8)
    v_mfma_f32_32x32x16_bf16 v[208:223], a[8:11], a[64:67], v[208:223]
    ds_read_b64_tr_b16 a[88:89], v57 offset:36864
    ds_read_b64_tr_b16 a[90:91], v57 offset:37120
    v_exp_f32 v240, v240
    v_exp_f32 v241, v241
    v_mfma_f32_32x32x16_bf16 v[208:223], a[12:15], a[68:71], v[208:223]
    ds_read_b64_tr_b16 a[92:93], v58 offset:36864
    ds_read_b64_tr_b16 a[94:95], v58 offset:37120
    v_exp_f32_e64 v242, v242
    v_exp_f32 v243, v243
    s_waitcnt lgkmcnt(8)
    v_mfma_f32_32x32x16_bf16 v[208:223], a[20:23], a[72:75], v[208:223]
    ds_read_b64_tr_b16 a[64:65], v56 offset:40960
    ds_read_b64_tr_b16 a[66:67], v56 offset:41216
    v_exp_f32 v244, v244
    v_exp_f32 v245, v245
    v_mfma_f32_32x32x16_bf16 v[208:223], a[24:27], a[76:79], v[208:223]
    ds_read_b64_tr_b16 a[68:69], v57 offset:40960
    ds_read_b64_tr_b16 a[70:71], v57 offset:41216
    v_exp_f32 v246, v246
    v_exp_f32_e64 v247, v247
    s_waitcnt lgkmcnt(8)
    v_mfma_f32_32x32x16_bf16 v[208:223], a[28:31], a[80:83], v[208:223]
    ds_read_b64_tr_b16 a[72:73], v58 offset:40960
    ds_read_b64_tr_b16 a[74:75], v58 offset:41216
    v_exp_f32 v248, v248
    v_exp_f32 v249, v249
    v_mfma_f32_32x32x16_bf16 v[208:223], a[36:39], a[84:87], v[208:223]
    ds_read_b64_tr_b16 a[76:77], v56 offset:45056
    ds_read_b64_tr_b16 a[78:79], v56 offset:45312
    v_exp_f32 v250, v250
    v_exp_f32 v251, v251
    v_pk_add_f32 v[78:79], v[224:225], v[226:227]
    v_pk_add_f32 v[80:81], v[238:239], v[240:241]
    v_pk_add_f32 v[78:79], v[78:79], v[228:229]
    v_pk_add_f32 v[80:81], v[80:81], v[242:243]
    v_pk_add_f32 v[78:79], v[78:79], v[230:231]
    v_pk_add_f32 v[80:81], v[80:81], v[244:245]
    v_pk_add_f32 v[78:79], v[78:79], v[232:233]
    v_pk_add_f32 v[80:81], v[80:81], v[246:247]
    v_pk_add_f32 v[78:79], v[78:79], v[234:235]
    v_pk_add_f32 v[80:81], v[80:81], v[248:249]
    v_pk_add_f32 v[78:79], v[78:79], v[236:237]
    v_pk_add_f32 v[80:81], v[80:81], v[250:251]
    v_dot2c_f32_bf16 v70, v160, v14
    v_dot2c_f32_bf16 v70, v161, v14
    v_dot2c_f32_bf16 v70, v162, v14
    v_dot2c_f32_bf16 v70, v163, v14
    v_dot2c_f32_bf16 v70, v164, v14
    v_dot2c_f32_bf16 v70, v165, v14
    v_dot2c_f32_bf16 v70, v166, v14
    v_dot2c_f32_bf16 v70, v167, v14
    v_dot2c_f32_bf16 v70, v168, v14
    v_dot2c_f32_bf16 v70, v169, v14
    v_dot2c_f32_bf16 v70, v170, v14
    v_dot2c_f32_bf16 v70, v171, v14
    v_dot2c_f32_bf16 v70, v172, v14
    v_dot2c_f32_bf16 v70, v173, v14
    v_dot2c_f32_bf16 v70, v174, v14
    v_dot2c_f32_bf16 v70, v175, v14
    v_dot2c_f32_bf16 v70, v176, v14
    v_dot2c_f32_bf16 v70, v177, v14
    v_dot2c_f32_bf16 v70, v178, v14
    v_dot2c_f32_bf16 v70, v179, v14
    v_dot2c_f32_bf16 v70, v180, v14
    v_dot2c_f32_bf16 v70, v181, v14
    v_dot2c_f32_bf16 v70, v182, v14
    v_dot2c_f32_bf16 v70, v183, v14
    v_dot2c_f32_bf16 v70, v184, v14
    v_dot2c_f32_bf16 v70, v185, v14
    v_dot2c_f32_bf16 v70, v186, v14
    v_dot2c_f32_bf16 v70, v187, v14
    s_waitcnt lgkmcnt(8)
    v_mfma_f32_32x32x16_bf16 v[208:223], a[40:43], a[88:91], v[208:223]
    ds_read_b64_tr_b16 a[80:81], v57 offset:45056
    ds_read_b64_tr_b16 a[82:83], v57 offset:45312
    v_add_f32 v76, v78, v79
    v_add_f32_e64 v77, v80, v81
    ds_write_b32 v65, v70 offset:1024
    ds_read_b128 v[192:195], v64 offset:0
    v_mfma_f32_32x32x16_bf16 v[208:223], a[44:47], a[92:95], v[208:223]
    ds_read_b64_tr_b16 a[84:85], v58 offset:45056
    ds_read_b64_tr_b16 a[86:87], v58 offset:45312
    ds_read_b128 v[196:199], v64 offset:32
    ds_read_b128 v[200:203], v64 offset:64
    ds_read_b128 v[204:207], v64 offset:96
    s_waitcnt lgkmcnt(13)
    v_mfma_f32_32x32x16_bf16 v[208:223], v[148:151], a[64:67], v[208:223]
    ds_read_b64_tr_b16 a[88:89], v56 offset:49152
    ds_read_b64_tr_b16 a[90:91], v56 offset:49408
    v_permlane32_swap_b32 v76, v77
    v_add_f32_e64 v76, v76, v77
    v_mfma_f32_32x32x16_bf16 v[208:223], v[152:155], a[68:71], v[208:223]
    ds_read_b64_tr_b16 a[92:93], v57 offset:49152
    ds_read_b64_tr_b16 a[94:95], v57 offset:49408
    v_rcp_f32 v78, v76
    v_rcp_f32 v80, v76
    s_nop 1
    v_permlane32_swap_b32 v78, v80
    v_pk_mul_f32 v[224:225], v[224:225], v[78:79] op_sel_hi:[1,0]
    v_pk_mul_f32 v[226:227], v[226:227], v[78:79] op_sel_hi:[1,0]
    v_pk_mul_f32 v[228:229], v[228:229], v[78:79] op_sel_hi:[1,0]
    v_pk_mul_f32 v[230:231], v[230:231], v[78:79] op_sel_hi:[1,0]
    v_pk_mul_f32 v[232:233], v[232:233], v[78:79] op_sel_hi:[1,0]
    v_pk_mul_f32 v[234:235], v[234:235], v[78:79] op_sel_hi:[1,0]
    v_pk_mul_f32 v[236:237], v[236:237], v[78:79] op_sel_hi:[1,0]
    v_pk_mul_f32 v[238:239], v[238:239], v[80:81] op_sel_hi:[1,0]
    v_pk_mul_f32 v[240:241], v[240:241], v[80:81] op_sel_hi:[1,0]
    v_pk_mul_f32 v[242:243], v[242:243], v[80:81] op_sel_hi:[1,0]
    v_pk_mul_f32 v[244:245], v[244:245], v[80:81] op_sel_hi:[1,0]
    v_pk_mul_f32 v[246:247], v[246:247], v[80:81] op_sel_hi:[1,0]
    v_pk_mul_f32 v[248:249], v[248:249], v[80:81] op_sel_hi:[1,0]
    v_pk_mul_f32 v[250:251], v[250:251], v[80:81] op_sel_hi:[1,0]
    s_waitcnt lgkmcnt(0)
    s_barrier
    v_mfma_f32_32x32x16_bf16 v[208:223], v[156:159], a[72:75], v[208:223]
    ds_read_b64_tr_b16 a[64:65], v58 offset:49152
    ds_read_b64_tr_b16 a[66:67], v58 offset:49408
    ds_read_b32 v2, v66 offset:1024
    ds_read_b32 v3, v66 offset:1280
    ds_read_b32 v4, v66 offset:1536
    ds_read_b32 v5, v66 offset:1792
    v_mfma_f32_32x32x16_bf16 v[208:223], v[100:103], a[76:79], v[208:223]
    ds_read_b64_tr_b16 a[68:69], v56 offset:53248
    ds_read_b64_tr_b16 a[70:71], v56 offset:53504
    v_cvt_pk_bf16_f32 v28, v224, v225
    v_cvt_pk_bf16_f32 v29, v226, v227
    v_cvt_pk_bf16_f32 v30, v228, v229
    v_cvt_pk_bf16_f32 v31, v230, v231
    v_mfma_f32_32x32x16_bf16 v[208:223], v[104:107], a[80:83], v[208:223]
    ds_read_b64_tr_b16 a[72:73], v57 offset:53248
    ds_read_b64_tr_b16 a[74:75], v57 offset:53504
    v_cvt_pk_bf16_f32 v32, v232, v233
    v_cvt_pk_bf16_f32 v33, v234, v235
    v_cvt_pk_bf16_f32 v34, v236, v237
    ds_write_b64 v62, v[28:29] offset:0
    v_mfma_f32_32x32x16_bf16 v[208:223], v[108:111], a[84:87], v[208:223]
    ds_read_b64_tr_b16 a[76:77], v58 offset:53248
    ds_read_b64_tr_b16 a[78:79], v58 offset:53504
    ds_write_b64 v62, v[30:31] offset:16
    ds_write_b64 v62, v[32:33] offset:32
    ds_write_b64 v62, v[34:35] offset:48
    s_waitcnt lgkmcnt(12)
    v_add_f32 v2, v2, v3
    v_mfma_f32_32x32x16_bf16 v[208:223], v[116:119], a[88:91], v[208:223]
    s_waitcnt lgkmcnt(10)
    v_add_f32_e64 v4, v4, v5
    v_add_f32 v2, v2, v4
    v_cvt_pk_bf16_f32 v3, v2, v2
    v_and_b32 v3, 0xffff0000, v3
    v_sub_f32_e64 v3, v2, v3
    v_cvt_pk_bf16_f32 v92, v2, v3
    v_mfma_f32_32x32x16_bf16 v[208:223], v[120:123], a[92:95], v[208:223]
    v_mov_b32 v93, v92
    v_cvt_pk_bf16_f32 v36, v238, v239
    v_cvt_pk_bf16_f32 v37, v240, v241
    v_cvt_pk_bf16_f32 v38, v242, v243
    v_cvt_pk_bf16_f32 v39, v244, v245
    v_cvt_pk_bf16_f32 v40, v246, v247
    s_waitcnt lgkmcnt(8)
    v_mfma_f32_32x32x16_bf16 v[208:223], v[124:127], a[64:67], v[208:223]
    v_cvt_pk_bf16_f32 v41, v248, v249
    v_cvt_pk_bf16_f32 v42, v250, v251
    ds_write_b64 v62, v[36:37] offset:64
    ds_write_b64 v62, v[38:39] offset:80
    ds_write_b64 v62, v[40:41] offset:96
    ds_write_b64 v62, v[42:43] offset:112
    v_mfma_f32_32x32x16_bf16 v[208:223], v[132:135], a[68:71], v[208:223]
    s_add_u32 s12, s17, 155648
    v_add_u32_e64 v4, s12, v6
    s_waitcnt lgkmcnt(7)
    v_mfma_f32_32x32x16_bf16 v[208:223], v[136:139], a[72:75], v[208:223]
    v_mfma_f32_32x32x16_bf16 v[208:223], v[140:143], a[76:79], v[208:223]
    v_mfma_f32_32x32x16_bf16 v[208:223], v[84:87], v[92:95], v[208:223]
    v_add_u32 v55, 57344, v55
    v_add_u32 v56, 57344, v56
    v_add_u32 v57, 57344, v57
    v_add_u32 v58, 57344, v58
    s_lshl_b32 s12, s5, 4
    s_add_u32 s12, s12, s6
    s_lshl_b32 s12, s12, 12
    s_add_u32 s12, s12, s16
    s_nop 3
    v_pk_mul_f32 v[208:209], v[208:209], v[192:193]
    v_pk_mul_f32 v[210:211], v[210:211], v[194:195]
    v_pk_mul_f32 v[212:213], v[212:213], v[196:197]
    v_pk_mul_f32 v[214:215], v[214:215], v[198:199]
    v_cvt_pk_bf16_f32 v160, v208, v209
    v_cvt_pk_bf16_f32 v161, v210, v211
    v_cvt_pk_bf16_f32 v162, v212, v213
    v_cvt_pk_bf16_f32 v163, v214, v215
    v_cndmask_b32 v160, v160, v14, s[96:97]
    v_cndmask_b32 v161, v161, v14, s[96:97]
    v_cndmask_b32 v162, v162, v14, s[96:97]
    v_cndmask_b32 v163, v163, v14, s[96:97]
    ds_write_b128 v4, v[160:163] offset:0
    v_pk_mul_f32 v[216:217], v[216:217], v[200:201]
    v_pk_mul_f32 v[218:219], v[218:219], v[202:203]
    v_pk_mul_f32 v[220:221], v[220:221], v[204:205]
    v_pk_mul_f32 v[222:223], v[222:223], v[206:207]
    v_cvt_pk_bf16_f32 v164, v216, v217
    v_cvt_pk_bf16_f32 v165, v218, v219
    v_cvt_pk_bf16_f32 v166, v220, v221
    v_cvt_pk_bf16_f32 v167, v222, v223
    v_cndmask_b32 v164, v164, v14, s[96:97]
    v_cndmask_b32 v165, v165, v14, s[96:97]
    v_cndmask_b32 v166, v166, v14, s[96:97]
    v_cndmask_b32 v167, v167, v14, s[96:97]
    ds_write_b128 v4, v[164:167] offset:1024
    s_waitcnt lgkmcnt(0)
    s_barrier
    ds_read_b64_tr_b16 v[192:193], v60 offset:0
    ds_read_b64_tr_b16 v[194:195], v60 offset:1088
    ds_read_b128 v[220:223], v61 offset:0
    ds_read_b128 v[224:227], v61 offset:256
    ds_read_b64_tr_b16 v[196:197], v60 offset:4352
    ds_read_b64_tr_b16 v[198:199], v60 offset:5440
    ds_read_b128 v[228:231], v61 offset:2048
    ds_read_b128 v[232:235], v61 offset:2304
    ds_read_b64_tr_b16 v[200:201], v60 offset:8704
    ds_read_b64_tr_b16 v[202:203], v60 offset:9792
    ds_read_b128 v[236:239], v61 offset:4096
    ds_read_b128 v[240:243], v61 offset:4352
    ds_read_b64_tr_b16 v[204:205], v60 offset:13056
    ds_read_b64_tr_b16 v[206:207], v60 offset:14144
    ds_read_b128 v[244:247], v61 offset:6144
    ds_read_b128 v[248:251], v61 offset:6400
    s_waitcnt lgkmcnt(13)
    v_mfma_f32_16x16x32_bf16 v[28:31], v[192:195], v[220:223], 0
    s_waitcnt lgkmcnt(12)
    v_mfma_f32_16x16x32_bf16 v[32:35], v[192:195], v[224:227], 0
    s_waitcnt lgkmcnt(9)
    v_mfma_f32_16x16x32_bf16 v[28:31], v[196:199], v[228:231], v[28:31]
    s_waitcnt lgkmcnt(8)
    v_mfma_f32_16x16x32_bf16 v[32:35], v[196:199], v[232:235], v[32:35]
    s_waitcnt lgkmcnt(5)
    v_mfma_f32_16x16x32_bf16 v[28:31], v[200:203], v[236:239], v[28:31]
    s_waitcnt lgkmcnt(4)
    v_mfma_f32_16x16x32_bf16 v[32:35], v[200:203], v[240:243], v[32:35]
    s_waitcnt lgkmcnt(1)
    v_mfma_f32_16x16x32_bf16 v[28:31], v[204:207], v[244:247], v[28:31]
    s_waitcnt lgkmcnt(0)
    v_mfma_f32_16x16x32_bf16 v[32:35], v[204:207], v[248:251], v[32:35]
    s_nop 5
    v_cvt_pk_bf16_f32 v36, v28, v29
    v_cvt_pk_bf16_f32 v37, v30, v31
    v_cvt_pk_bf16_f32 v38, v32, v33
    v_cvt_pk_bf16_f32 v39, v34, v35
    s_nop 0
    v_permlane32_swap_b32 v36, v38
    v_permlane32_swap_b32_e64 v37, v39
    buffer_store_dwordx4 v[36:39], v6, s[60:63], s12 offen sc1
    s_waitcnt vmcnt(3)
    ds_read_b64_tr_b16 v[160:161], v55 offset:0
    ds_read_b64_tr_b16 v[162:163], v55 offset:256
    ds_read_b64_tr_b16 v[164:165], v55 offset:4096
    ds_read_b64_tr_b16 v[166:167], v55 offset:4352
    ds_read_b64_tr_b16 v[168:169], v55 offset:8192
    ds_read_b64_tr_b16 v[170:171], v55 offset:8448
    ds_read_b64_tr_b16 v[172:173], v55 offset:12288
    ds_read_b64_tr_b16 v[174:175], v55 offset:12544
    ds_read_b64_tr_b16 v[176:177], v55 offset:16384
    ds_read_b64_tr_b16 v[178:179], v55 offset:16640
    ds_read_b64_tr_b16 v[180:181], v55 offset:20480
    ds_read_b64_tr_b16 v[182:183], v55 offset:20736
    s_barrier
    s_and_b32 s12, s2, 7
    s_lshr_b32 s8, s3, 2
    s_lshl_b32 s13, s8, 7
    s_mul_i32 s25, s4, 107520
    s_add_u32 s25, s25, s13
    s_mul_i32 s18, s4, 15360
    v_lshrrev_b32 v2, 2, v1
    v_lshrrev_b32 v3, 4, v1
    v_xor_b32 v2, v2, v3
    v_and_b32 v2, 1, v2
    v_and_b32 v3, 3, v1
    v_lshlrev_b32 v3, 4, v3
    s_waitcnt lgkmcnt(8)
    v_mfma_f32_32x32x16_bf16 v[208:223], v[160:163], a[0:3], 0
    ds_read_b64_tr_b16 v[184:185], v55 offset:24576
    ds_read_b64_tr_b16 v[186:187], v55 offset:24832
    v_lshl_add_u32 v19, v2, 6, v3
    v_lshrrev_b32 v2, 3, v1
    v_mul_u32_u24 v2, 896, v2
    v_add_u32 v15, v2, v19
    v_mfma_f32_32x32x16_bf16 v[208:223], v[164:167], a[16:19], v[208:223]
    ds_read_b64_tr_b16 a[92:93], v56 offset:0
    ds_read_b64_tr_b16 a[94:95], v56 offset:256
    v_lshl_add_u32 v19, v2, 2, v19
    v_add_u32 v16, 6144, v15
    v_add_u32 v17, 12288, v15
    v_add_u32 v18, 18432, v15
    s_waitcnt lgkmcnt(8)
    v_mfma_f32_32x32x16_bf16 v[208:223], v[168:171], a[32:35], v[208:223]
    ds_read_b64_tr_b16 a[64:65], v57 offset:0
    ds_read_b64_tr_b16 a[66:67], v57 offset:256
    s_lshl_b32 s26, s4, 12
    s_lshl_b32 s13, s4, 9
    v_lshl_add_u32 v2, v1, 7, s13
    v_lshrrev_b32 v3, 2, v1
    v_mfma_f32_32x32x16_bf16 v[208:223], v[172:175], v[144:147], v[208:223]
    ds_read_b64_tr_b16 a[68:69], v58 offset:0
    ds_read_b64_tr_b16 a[70:71], v58 offset:256
    v_lshl_add_u32 v10, v3, 28, v2
    s_lshl_b32 s13, s5, 11
    s_add_u32 s13, s13, 1048576
    s_lshl_b32 s99, s6, 2
    s_waitcnt lgkmcnt(8)
    v_mfma_f32_32x32x16_bf16 v[208:223], v[176:179], v[96:99], v[208:223]
    ds_read_b64_tr_b16 a[72:73], v56 offset:4096
    ds_read_b64_tr_b16 a[74:75], v56 offset:4352
    s_add_u32 s37, s13, s99
    s_lshl_b32 s99, s6, 7
    s_add_u32 s27, s13, s99
    v_mfma_f32_32x32x16_bf16 v[208:223], v[180:183], v[112:115], v[208:223]
    ds_read_b64_tr_b16 a[76:77], v57 offset:4096
    ds_read_b64_tr_b16 a[78:79], v57 offset:4352
    s_waitcnt lgkmcnt(8)
    v_mfma_f32_32x32x16_bf16 v[208:223], v[184:187], v[128:131], v[208:223]
    ds_read_b64_tr_b16 a[80:81], v58 offset:4096
    ds_read_b64_tr_b16 a[82:83], v58 offset:4352
    v_dot2c_f32_bf16 v71, v160, v14
    v_dot2c_f32_bf16 v71, v161, v14
    v_dot2c_f32_bf16 v71, v162, v14
    v_dot2c_f32_bf16 v71, v163, v14
    v_dot2c_f32_bf16 v71, v164, v14
    v_dot2c_f32_bf16 v71, v165, v14
    v_dot2c_f32_bf16 v71, v166, v14
    v_dot2c_f32_bf16 v71, v167, v14
    v_dot2c_f32_bf16 v71, v168, v14
    v_dot2c_f32_bf16 v71, v169, v14
    v_dot2c_f32_bf16 v71, v170, v14
    v_dot2c_f32_bf16 v71, v171, v14
    v_dot2c_f32_bf16 v71, v172, v14
    v_dot2c_f32_bf16 v71, v173, v14
    v_dot2c_f32_bf16 v71, v174, v14
    v_dot2c_f32_bf16 v71, v175, v14
    v_dot2c_f32_bf16 v71, v176, v14
    v_dot2c_f32_bf16 v71, v177, v14
    v_dot2c_f32_bf16 v71, v178, v14
    v_dot2c_f32_bf16 v71, v179, v14
    v_dot2c_f32_bf16 v71, v180, v14
    v_dot2c_f32_bf16 v71, v181, v14
    v_dot2c_f32_bf16 v71, v182, v14
    v_dot2c_f32_bf16 v71, v183, v14
    v_dot2c_f32_bf16 v71, v184, v14
    v_dot2c_f32_bf16 v71, v185, v14
    v_dot2c_f32_bf16 v71, v186, v14
    v_dot2c_f32_bf16 v71, v187, v14
    s_nop 2
    ds_write_b32 v65, v71 offset:2048
    v_mfma_f32_32x32x16_bf16 v[208:223], a[92:95], a[4:7], v[208:223]
    ds_read_b64_tr_b16 a[84:85], v56 offset:8192
    ds_read_b64_tr_b16 a[86:87], v56 offset:8448
    s_waitcnt lgkmcnt(9)
    v_mfma_f32_32x32x16_bf16 v[208:223], a[64:67], a[8:11], v[208:223]
    ds_read_b64_tr_b16 a[88:89], v57 offset:8192
    ds_read_b64_tr_b16 a[90:91], v57 offset:8448
    v_mfma_f32_32x32x16_bf16 v[208:223], a[68:71], a[12:15], v[208:223]
    ds_read_b64_tr_b16 a[92:93], v58 offset:8192
    ds_read_b64_tr_b16 a[94:95], v58 offset:8448
    s_waitcnt lgkmcnt(9)
    v_mfma_f32_32x32x16_bf16 v[208:223], a[72:75], a[20:23], v[208:223]
    ds_read_b64_tr_b16 a[64:65], v56 offset:12288
    ds_read_b64_tr_b16 a[66:67], v56 offset:12544
    s_add_u32 m0, s18, 86016
    s_add_u32 s92, s25, 0
    buffer_load_dwordx4 v15, s[52:55], s92 offen offset:0 lds
    v_mfma_f32_32x32x16_bf16 v[208:223], a[76:79], a[24:27], v[208:223]
    ds_read_b64_tr_b16 a[68:69], v57 offset:12288
    ds_read_b64_tr_b16 a[70:71], v57 offset:12544
    s_waitcnt lgkmcnt(8)
    v_mfma_f32_32x32x16_bf16 v[208:223], a[80:83], a[28:31], v[208:223]
    ds_read_b64_tr_b16 a[72:73], v58 offset:12288
    ds_read_b64_tr_b16 a[74:75], v58 offset:12544
    buffer_load_dwordx4 v16, s[52:55], s92 offen offset:1024 lds
    v_cmp_eq_u32 vcc, 0, v7
    s_mov_b32 s13, 0
    s_cbranch_vccnz L_epoch
L_epoch_done:
    s_waitcnt vmcnt(2)
    s_barrier
    buffer_store_dword v7, v10, s[60:63], s37 offen sc1
    v_mfma_f32_32x32x16_bf16 v[208:223], a[84:87], a[36:39], v[208:223]
    ds_read_b64_tr_b16 a[76:77], v56 offset:16384
    ds_read_b64_tr_b16 a[78:79], v56 offset:16640
    buffer_load_dwordx4 v17, s[52:55], s92 offen offset:2048 lds
    s_waitcnt lgkmcnt(8)
    v_mfma_f32_32x32x16_bf16 v[208:223], a[88:91], a[40:43], v[208:223]
    ds_read_b64_tr_b16 a[80:81], v57 offset:16384
    ds_read_b64_tr_b16 a[82:83], v57 offset:16640
    ds_read_b32 v76, v66 offset:2048
    ds_read_b32 v77, v66 offset:2304
    ds_read_b32 v78, v66 offset:2560
    ds_read_b32 v79, v66 offset:2816
    v_readfirstlane_b32 s22, v7
    v_mfma_f32_32x32x16_bf16 v[208:223], a[92:95], a[44:47], v[208:223]
    ds_read_b64_tr_b16 a[84:85], v58 offset:16384
    ds_read_b64_tr_b16 a[86:87], v58 offset:16640
    buffer_load_dwordx4 v18, s[52:55], s92 offen offset:3072 lds
    s_waitcnt lgkmcnt(12)
    v_mfma_f32_32x32x16_bf16 v[208:223], a[64:67], v[148:151], v[208:223]
    ds_read_b64_tr_b16 a[88:89], v56 offset:20480
    ds_read_b64_tr_b16 a[90:91], v56 offset:20736
    v_readfirstlane_b32 s23, v7
    s_waitcnt lgkmcnt(6)
    v_add_f32 v76, v76, v77
    s_waitcnt lgkmcnt(4)
    v_add_f32 v78, v78, v79
    v_add_f32 v76, v76, v78
    v_cvt_pk_bf16_f32 v77, v76, v76
    v_mfma_f32_32x32x16_bf16 v[208:223], a[68:71], v[152:155], v[208:223]
    ds_read_b64_tr_b16 a[92:93], v57 offset:20480
    ds_read_b64_tr_b16 a[94:95], v57 offset:20736
    s_add_u32 m0, s18, 90112
    s_add_u32 s92, s25, 28672
    buffer_load_dwordx4 v15, s[52:55], s92 offen offset:0 lds
    v_mfma_f32_32x32x16_bf16 v[208:223], a[72:75], v[156:159], v[208:223]
    ds_read_b64_tr_b16 a[64:65], v58 offset:20480
    ds_read_b64_tr_b16 a[66:67], v58 offset:20736
    v_and_b32 v77, 0xffff0000, v77
    v_sub_f32_e64 v77, v76, v77
    v_cvt_pk_bf16_f32 v88, v76, v77
    v_mov_b32 v89, v88
    s_and_b32 s9, s3, 3
    v_mfma_f32_32x32x16_bf16 v[208:223], a[76:79], v[100:103], v[208:223]
    ds_read_b64_tr_b16 a[68:69], v56 offset:24576
    ds_read_b64_tr_b16 a[70:71], v56 offset:24832
    buffer_load_dwordx4 v16, s[52:55], s92 offen offset:1024 lds
    s_waitcnt lgkmcnt(8)
    v_mfma_f32_32x32x16_bf16 v[208:223], a[80:83], v[104:107], v[208:223]
    ds_read_b64_tr_b16 a[72:73], v57 offset:24576
    ds_read_b64_tr_b16 a[74:75], v57 offset:24832
    s_lshl_b32 s13, s12, 2
    s_add_u32 s9, s9, s13
    s_and_b32 s10, s2, 1
    s_mul_i32 s10, s10, 7
    s_add_u32 s10, s10, s8
    v_mfma_f32_32x32x16_bf16 v[208:223], a[84:87], v[108:111], v[208:223]
    ds_read_b64_tr_b16 a[76:77], v58 offset:24576
    ds_read_b64_tr_b16 a[78:79], v58 offset:24832
    buffer_load_dwordx4 v17, s[52:55], s92 offen offset:2048 lds
    s_waitcnt lgkmcnt(8)
    v_mfma_f32_32x32x16_bf16 v[208:223], a[88:91], v[116:119], v[208:223]
    s_lshr_b32 s13, s4, 1
    s_lshl_b32 s19, s9, 1
    s_add_u32 s19, s19, s13
    s_and_b32 s13, s4, 1
    s_lshl_b32 s20, s8, 1
    s_add_u32 s20, s20, s13
    v_and_b32 v2, 31, v1
    v_mfma_f32_32x32x16_bf16 v[208:223], a[92:95], v[120:123], v[208:223]
    buffer_load_dwordx4 v18, s[52:55], s92 offen offset:3072 lds
    v_lshlrev_b32_e64 v4, 1, v2
    s_lshl_b32 s99, s10, 8
    s_waitcnt lgkmcnt(4)
    v_mfma_f32_32x32x16_bf16 v[208:223], a[64:67], v[124:127], v[208:223]
    v_mfma_f32_32x32x16_bf16 v[208:223], a[68:71], v[132:135], v[208:223]
    s_add_u32 m0, s18, 94208
    s_add_u32 s92, s25, 57344
    buffer_load_dwordx4 v15, s[52:55], s92 offen offset:0 lds
    s_waitcnt lgkmcnt(0)
    v_mfma_f32_32x32x16_bf16 v[208:223], a[72:75], v[136:139], v[208:223]
    v_mfma_f32_32x32x16_bf16 v[208:223], a[76:79], v[140:143], v[208:223]
    buffer_load_dwordx4 v16, s[52:55], s92 offen offset:1024 lds
    v_mfma_f32_32x32x16_bf16 v[208:223], v[88:91], v[84:87], v[208:223]
    buffer_load_dwordx4 v17, s[52:55], s92 offen offset:2048 lds
    buffer_load_dwordx4 v18, s[52:55], s92 offen offset:3072 lds
    s_nop 9
    v_cvt_pk_bf16_f32 v160, v208, v209
    v_cvt_pk_bf16_f32 v161, v210, v211
    v_cvt_pk_bf16_f32 v162, v212, v213
    v_cvt_pk_bf16_f32 v163, v214, v215
    v_cvt_pk_bf16_f32 v164, v216, v217
    v_cvt_pk_bf16_f32 v165, v218, v219
    v_cvt_pk_bf16_f32 v166, v220, v221
    v_cvt_pk_bf16_f32 v167, v222, v223
    v_mfma_f32_32x32x16_bf16 v[192:207], a[48:51], v[160:163], 0
    s_add_u32 m0, s18, 98304
    s_add_u32 s92, s25, 86016
    buffer_load_dwordx4 v15, s[52:55], s92 offen offset:0 lds
    v_mfma_f32_32x32x16_bf16 v[192:207], a[52:55], v[164:167], v[192:207]
    buffer_load_dwordx4 v16, s[52:55], s92 offen offset:1024 lds
    buffer_load_dwordx4 v17, s[52:55], s92 offen offset:2048 lds
    s_barrier
    v_mov_b32 v84, 0
    buffer_load_ushort a112, v4, s[56:59], s99 offen offset:0
    v_mov_b32 v85, 0
    v_mov_b32 v86, 0
    v_mov_b32 v87, 0
    v_mov_b32 v88, 0
    v_mov_b32 v89, 0
    buffer_load_ushort a113, v4, s[56:59], s99 offen offset:64
    v_mov_b32 v90, 0
    v_mov_b32 v91, 0
    v_mov_b32 v67, 0x00003f80
    v_mov_b32 v68, 0x3f800000
    s_lshl_b32 s14, s5, 16
    buffer_load_ushort a114, v4, s[56:59], s99 offen offset:128
    s_add_u32 s14, s14, s16
    buffer_load_ushort a115, v4, s[56:59], s99 offen offset:192
    s_load_dwordx16 s[44:59], s[0:1], s27 glc
    v_max3_f32 v76, v192, v193, v194
    v_min3_f32 v77, v192, v193, v194
    v_max3_f32 v76, v76, v195, v196
    v_min3_f32 v77, v77, v195, v196
    v_max3_f32 v76, v76, v197, v198
    v_min3_f32 v77, v77, v197, v198
    v_max3_f32 v76, v76, v199, v200
    v_min3_f32 v77, v77, v199, v200
    v_max3_f32 v76, v76, v201, v202
    v_min3_f32 v77, v77, v201, v202
    v_max3_f32 v76, v76, v203, v204
    v_min3_f32 v77, v77, v203, v204
    v_max_f32_e64 v76, v76, v205
    v_max_f32 v77, -v77, -v205
    v_mov_b32 v35, 0
    v_mov_b32 v43, 0
    v_permlane32_swap_b32 v76, v77
    v_max_f32 v76, v76, v77
    v_mul_f32 v78, v76, v74
    v_mul_f32 v80, v76, v74
    s_nop 1
    v_permlane32_swap_b32 v78, v80
    v_pk_fma_f32 v[224:225], v[192:193], v[74:75], v[78:79] op_sel_hi:[1,0,0] neg_lo:[0,0,1] neg_hi:[0,0,1]
    v_pk_fma_f32 v[238:239], v[192:193], v[74:75], v[80:81] op_sel_hi:[1,0,0] neg_lo:[1,0,1] neg_hi:[1,0,1]
    v_pk_fma_f32 v[226:227], v[194:195], v[74:75], v[78:79] op_sel_hi:[1,0,0] neg_lo:[0,0,1] neg_hi:[0,0,1]
    v_pk_fma_f32 v[240:241], v[194:195], v[74:75], v[80:81] op_sel_hi:[1,0,0] neg_lo:[1,0,1] neg_hi:[1,0,1]
    v_pk_fma_f32 v[228:229], v[196:197], v[74:75], v[78:79] op_sel_hi:[1,0,0] neg_lo:[0,0,1] neg_hi:[0,0,1]
    v_pk_fma_f32 v[242:243], v[196:197], v[74:75], v[80:81] op_sel_hi:[1,0,0] neg_lo:[1,0,1] neg_hi:[1,0,1]
    v_pk_fma_f32 v[230:231], v[198:199], v[74:75], v[78:79] op_sel_hi:[1,0,0] neg_lo:[0,0,1] neg_hi:[0,0,1]
    v_pk_fma_f32 v[244:245], v[198:199], v[74:75], v[80:81] op_sel_hi:[1,0,0] neg_lo:[1,0,1] neg_hi:[1,0,1]
    v_pk_fma_f32 v[232:233], v[200:201], v[74:75], v[78:79] op_sel_hi:[1,0,0] neg_lo:[0,0,1] neg_hi:[0,0,1]
    v_pk_fma_f32 v[246:247], v[200:201], v[74:75], v[80:81] op_sel_hi:[1,0,0] neg_lo:[1,0,1] neg_hi:[1,0,1]
    v_pk_fma_f32 v[234:235], v[202:203], v[74:75], v[78:79] op_sel_hi:[1,0,0] neg_lo:[0,0,1] neg_hi:[0,0,1]
    v_pk_fma_f32 v[248:249], v[202:203], v[74:75], v[80:81] op_sel_hi:[1,0,0] neg_lo:[1,0,1] neg_hi:[1,0,1]
    v_pk_fma_f32 v[236:237], v[204:205], v[74:75], v[78:79] op_sel_hi:[1,0,0] neg_lo:[0,0,1] neg_hi:[0,0,1]
    v_pk_fma_f32 v[250:251], v[204:205], v[74:75], v[80:81] op_sel_hi:[1,0,0] neg_lo:[1,0,1] neg_hi:[1,0,1]
    v_exp_f32 v224, v224
    v_exp_f32 v225, v225
    v_exp_f32 v226, v226
    v_exp_f32 v227, v227
    v_exp_f32 v228, v228
    v_exp_f32 v229, v229
    v_exp_f32 v230, v230
    v_exp_f32 v231, v231
    v_exp_f32 v232, v232
    v_exp_f32 v233, v233
    v_exp_f32 v234, v234
    v_exp_f32 v235, v235
    v_exp_f32 v236, v236
    v_exp_f32_e64 v237, v237
    s_mov_b32 s13, 0
    s_waitcnt lgkmcnt(0)
    s_xor_b64 s[44:45], s[44:45], s[22:23]
    s_xor_b64 s[46:47], s[46:47], s[22:23]
    s_xor_b64 s[48:49], s[48:49], s[22:23]
    s_xor_b64 s[50:51], s[50:51], s[22:23]
    s_xor_b64 s[52:53], s[52:53], s[22:23]
    s_xor_b64 s[54:55], s[54:55], s[22:23]
    s_xor_b64 s[56:57], s[56:57], s[22:23]
    s_xor_b64 s[58:59], s[58:59], s[22:23]
    s_or_b64 s[44:45], s[44:45], s[46:47]
    s_or_b64 s[44:45], s[44:45], s[48:49]
    s_or_b64 s[44:45], s[44:45], s[50:51]
    s_or_b64 s[44:45], s[44:45], s[52:53]
    s_or_b64 s[44:45], s[44:45], s[54:55]
    s_or_b64 s[44:45], s[44:45], s[56:57]
    s_or_b64 s[44:45], s[44:45], s[58:59]
    s_cbranch_scc1 L_sp0
L_sp0_done:
    s_add_u32 s12, s14, 0
    buffer_load_dwordx4 v[96:99], v6, s[60:63], s12 offen sc1
    s_add_u32 s12, s14, 4096
    buffer_load_dwordx4 v[100:103], v6, s[60:63], s12 offen sc1
    s_add_u32 s12, s14, 8192
    buffer_load_dwordx4 v[104:107], v6, s[60:63], s12 offen sc1
    s_add_u32 s12, s14, 12288
    buffer_load_dwordx4 v[108:111], v6, s[60:63], s12 offen sc1
    s_add_u32 s12, s14, 16384
    buffer_load_dwordx4 v[112:115], v6, s[60:63], s12 offen sc1
    v_exp_f32_e64 v238, v238
    s_add_u32 s12, s14, 20480
    buffer_load_dwordx4 v[116:119], v6, s[60:63], s12 offen sc1
    v_exp_f32 v239, v239
    v_exp_f32 v240, v240
    v_exp_f32 v241, v241
    v_exp_f32 v242, v242
    s_add_u32 s12, s14, 24576
    buffer_load_dwordx4 v[120:123], v6, s[60:63], s12 offen sc1
    v_exp_f32 v243, v243
    v_exp_f32 v244, v244
    v_exp_f32 v245, v245
    v_exp_f32 v246, v246
    s_add_u32 s12, s14, 28672
    buffer_load_dwordx4 v[124:127], v6, s[60:63], s12 offen sc1
    v_exp_f32 v247, v247
    v_exp_f32 v248, v248
    v_exp_f32 v249, v249
    v_exp_f32 v250, v250
    s_add_u32 s12, s14, 32768
    buffer_load_dwordx4 v[128:131], v6, s[60:63], s12 offen sc1
    v_exp_f32_e64 v251, v251
    v_pk_add_f32 v[78:79], v[224:225], v[226:227]
    v_pk_add_f32 v[80:81], v[238:239], v[240:241]
    v_pk_add_f32 v[78:79], v[78:79], v[228:229]
    v_pk_add_f32 v[80:81], v[80:81], v[242:243]
    v_pk_add_f32 v[78:79], v[78:79], v[230:231]
    s_add_u32 s12, s14, 36864
    buffer_load_dwordx4 v[132:135], v6, s[60:63], s12 offen sc1
    v_pk_add_f32 v[80:81], v[80:81], v[244:245]
    v_pk_add_f32 v[78:79], v[78:79], v[232:233]
    v_pk_add_f32 v[80:81], v[80:81], v[246:247]
    v_pk_add_f32 v[78:79], v[78:79], v[234:235]
    v_pk_add_f32 v[80:81], v[80:81], v[248:249]
    v_pk_add_f32 v[78:79], v[78:79], v[236:237]
    v_pk_add_f32 v[80:81], v[80:81], v[250:251]
    v_add_f32_e64 v76, v78, v79
    s_add_u32 s12, s14, 40960
    buffer_load_dwordx4 v[136:139], v6, s[60:63], s12 offen sc1
    v_add_f32 v77, v80, v81
    s_nop 1
    v_permlane32_swap_b32 v76, v77
    v_add_f32 v76, v76, v77
    v_rcp_f32_e64 v78, v76
    s_add_u32 s12, s14, 45056
    buffer_load_dwordx4 v[140:143], v6, s[60:63], s12 offen sc1
    v_rcp_f32_e64 v80, v76
    s_nop 1
    v_permlane32_swap_b32 v78, v80
    v_pk_mul_f32 v[224:225], v[224:225], v[78:79] op_sel_hi:[1,0]
    v_pk_mul_f32 v[226:227], v[226:227], v[78:79] op_sel_hi:[1,0]
    s_add_u32 s12, s14, 49152
    buffer_load_dwordx4 v[144:147], v6, s[60:63], s12 offen sc1
    v_pk_mul_f32 v[228:229], v[228:229], v[78:79] op_sel_hi:[1,0]
    v_pk_mul_f32 v[230:231], v[230:231], v[78:79] op_sel_hi:[1,0]
    v_pk_mul_f32 v[232:233], v[232:233], v[78:79] op_sel_hi:[1,0]
    v_pk_mul_f32 v[234:235], v[234:235], v[78:79] op_sel_hi:[1,0]
    v_pk_mul_f32 v[236:237], v[236:237], v[78:79] op_sel_hi:[1,0]
    v_pk_mul_f32 v[238:239], v[238:239], v[80:81] op_sel_hi:[1,0]
    v_pk_mul_f32 v[240:241], v[240:241], v[80:81] op_sel_hi:[1,0]
    v_pk_mul_f32 v[242:243], v[242:243], v[80:81] op_sel_hi:[1,0]
    s_add_u32 s12, s14, 53248
    buffer_load_dwordx4 v[148:151], v6, s[60:63], s12 offen sc1
    v_pk_mul_f32 v[244:245], v[244:245], v[80:81] op_sel_hi:[1,0]
    v_pk_mul_f32 v[246:247], v[246:247], v[80:81] op_sel_hi:[1,0]
    v_pk_mul_f32 v[248:249], v[248:249], v[80:81] op_sel_hi:[1,0]
    v_pk_mul_f32 v[250:251], v[250:251], v[80:81] op_sel_hi:[1,0]
    v_cvt_pk_bf16_f32 v28, v224, v225
    v_cvt_pk_bf16_f32 v29, v226, v227
    v_cvt_pk_bf16_f32 v30, v228, v229
    v_cvt_pk_bf16_f32 v31, v230, v231
    s_add_u32 s12, s14, 57344
    buffer_load_dwordx4 v[152:155], v6, s[60:63], s12 offen sc1
    v_cvt_pk_bf16_f32 v32, v232, v233
    v_cvt_pk_bf16_f32 v33, v234, v235
    v_cvt_pk_bf16_f32 v34, v236, v237
    v_cvt_pk_bf16_f32 v36, v238, v239
    v_cvt_pk_bf16_f32 v37, v240, v241
    v_cvt_pk_bf16_f32 v38, v242, v243
    v_cvt_pk_bf16_f32 v39, v244, v245
    v_cvt_pk_bf16_f32 v40, v246, v247
    s_add_u32 s12, s14, 61440
    buffer_load_dwordx4 v[156:159], v6, s[60:63], s12 offen sc1
    v_cvt_pk_bf16_f32 v41, v248, v249
    v_cvt_pk_bf16_f32 v42, v250, v251
    s_and_b32 s15, s2, 7
    s_and_b32 s11, s3, 3
    s_and_b32 s13, s2, 6
    s_lshl_b32 s13, s13, 1
    s_add_u32 s11, s11, s13
    s_lshl_b32 s21, s11, 2
    s_add_u32 s21, s21, s4
    v_add_u32 v20, 27648, v19
    v_add_u32 v21, 55296, v19
    v_add_u32 v22, 82944, v19
    s_lshl_b32 s13, s10, 8
    s_mul_i32 s35, s4, 114688
    s_add_u32 s35, s35, s13
    s_mul_i32 s36, s4, 57344
    s_add_u32 s36, s36, s13
    s_lshl_b32 s99, s5, 2
    s_mov_b32 s94, 0x4c3b2a10
    s_mov_b32 s95, 0x98f7e6d5
    s_lshr_b64 s[94:95], s[94:95], s99
    s_and_b32 s99, s94, 15
    s_mov_b32 s95, 1081344
    s_cmp_ge_u32 s99, 10
    s_cselect_b32 s94, 1277912, s95
    s_lshl_b32 s99, s99, 2
    s_lshl_b32 s13, s6, 11
    s_add_u32 s13, s13, s99
    s_add_u32 s38, s13, s94
    s_lshl_b32 s13, s9, 10
    s_lshl_b32 s99, s8, 7
    s_add_u32 s13, s13, s99
    s_add_u32 s28, s13, 1081344
    s_add_u32 s27, s13, 1277952
    s_lshr_b32 s13, s9, 1
    s_lshl_b32 s13, s13, 11
    s_and_b32 s99, s9, 1
    s_mul_i32 s99, s99, 7
    s_add_u32 s99, s99, s8
    s_lshl_b32 s99, s99, 2
    s_add_u32 s13, s13, s99
    s_add_u32 s39, s13, 1114112
    s_lshl_b32 s13, s11, 11
    s_add_u32 s13, s13, 1114112
    s_lshl_b32 s99, s10, 2
    s_add_u32 s99, s99, 32768
    s_add_u32 s24, s13, s99
    s_lshl_b32 s99, s10, 7
    s_add_u32 s31, s13, s99
    v_min_u32 v9, 13, v1
    v_lshlrev_b32 v9, 2, v9
    v_and_b32 v2, 15, v1
    v_lshl_add_u32 v2, v13, 4, v2
    v_bfe_u32 v3, v1, 4, 1
    v_lshl_add_u32 v2, v3, 5, v2
    s_add_u32 s13, s16, 155648
    v_lshl_add_u32 v57, v2, 4, s13
    v_add_u32 v58, 155648, v6
    v_lshl_add_u32 v5, v13, 2, v11
    v_lshl_add_u32 v47, v5, 7, v12
    v_lshrrev_b32 v5, 1, v11
    v_lshl_add_u32 v47, v5, 6, v47
    s_and_b32 s13, s4, 1
    s_lshl_b32 s99, s13, 6
    v_xor_b32 v46, s99, v47
    v_xor_b32_e64 v56, 64, v46
    s_mul_i32 s99, s13, 3584
    s_add_u32 s99, s99, 86016
    v_add_u32 v63, s99, v46
    v_add_u32 v64, s99, v56
    s_mul_i32 s13, s13, 25088
    s_add_u32 s13, s13, 86016
    v_add_u32 v55, s13, v46
    v_add_u32 v56, s13, v56
    s_lshl_b32 s15, s7, 4
    s_add_u32 s15, s15, s5
    s_lshl_b32 s15, s15, 11
    s_add_u32 s15, s15, 2097152
    v_and_b32 v2, 31, v1
    v_mul_u32_u24 v2, 896, v2
    v_lshl_add_u32 v2, v13, 4, v2
    v_lshlrev_b32_e64 v5, 3, v13
    s_mul_i32 s12, s19, 28672
    s_lshl_b32 s13, s20, 6
    s_add_u32 s12, s12, s13
    buffer_load_dwordx4 a[96:99], v2, s[40:43], s12 offen offset:0
    buffer_load_dwordx4 a[100:103], v2, s[40:43], s12 offen offset:32
    buffer_load_dwordx2 a[104:105], v5, s[72:75], s13 offen offset:0
    buffer_load_dwordx2 a[106:107], v5, s[72:75], s13 offen offset:16
    buffer_load_dwordx2 a[108:109], v5, s[72:75], s13 offen offset:32
    buffer_load_dwordx2 a[110:111], v5, s[72:75], s13 offen offset:48
    s_waitcnt vmcnt(21)
    v_dot2c_f32_bf16 v84, v96, v67
    v_dot2c_f32_bf16 v85, v96, v68
    v_dot2c_f32_bf16 v86, v97, v67
    v_dot2c_f32_bf16 v87, v97, v68
    v_dot2c_f32_bf16 v88, v98, v67
    v_dot2c_f32_bf16 v89, v98, v68
    v_dot2c_f32_bf16 v90, v99, v67
    v_dot2c_f32_bf16 v91, v99, v68
    s_waitcnt vmcnt(20)
    v_dot2c_f32_bf16 v84, v100, v67
    v_dot2c_f32_bf16 v85, v100, v68
    v_dot2c_f32_bf16 v86, v101, v67
    v_dot2c_f32_bf16 v87, v101, v68
    v_dot2c_f32_bf16 v88, v102, v67
    v_dot2c_f32_bf16 v89, v102, v68
    v_dot2c_f32_bf16 v90, v103, v67
    v_dot2c_f32_bf16 v91, v103, v68
    s_waitcnt vmcnt(19)
    v_dot2c_f32_bf16 v84, v104, v67
    v_dot2c_f32_bf16 v85, v104, v68
    v_dot2c_f32_bf16 v86, v105, v67
    v_dot2c_f32_bf16 v87, v105, v68
    v_dot2c_f32_bf16 v88, v106, v67
    v_dot2c_f32_bf16 v89, v106, v68
    v_dot2c_f32_bf16 v90, v107, v67
    v_dot2c_f32_bf16 v91, v107, v68
    s_waitcnt vmcnt(18)
    v_dot2c_f32_bf16 v84, v108, v67
    v_dot2c_f32_bf16 v85, v108, v68
    v_dot2c_f32_bf16 v86, v109, v67
    v_dot2c_f32_bf16 v87, v109, v68
    v_dot2c_f32_bf16 v88, v110, v67
    v_dot2c_f32_bf16 v89, v110, v68
    v_dot2c_f32_bf16 v90, v111, v67
    v_dot2c_f32_bf16 v91, v111, v68
    s_waitcnt vmcnt(17)
    v_dot2c_f32_bf16 v84, v112, v67
    v_dot2c_f32_bf16 v85, v112, v68
    v_dot2c_f32_bf16 v86, v113, v67
    v_dot2c_f32_bf16 v87, v113, v68
    v_dot2c_f32_bf16 v88, v114, v67
    v_dot2c_f32_bf16 v89, v114, v68
    v_dot2c_f32_bf16 v90, v115, v67
    v_dot2c_f32_bf16 v91, v115, v68
    s_waitcnt vmcnt(16)
    v_dot2c_f32_bf16 v84, v116, v67
    v_dot2c_f32_bf16 v85, v116, v68
    v_dot2c_f32_bf16 v86, v117, v67
    v_dot2c_f32_bf16 v87, v117, v68
    v_dot2c_f32_bf16 v88, v118, v67
    v_dot2c_f32_bf16 v89, v118, v68
    v_dot2c_f32_bf16 v90, v119, v67
    v_dot2c_f32_bf16 v91, v119, v68
    s_waitcnt vmcnt(15)
    v_dot2c_f32_bf16 v84, v120, v67
    v_dot2c_f32_bf16 v85, v120, v68
    v_dot2c_f32_bf16 v86, v121, v67
    v_dot2c_f32_bf16 v87, v121, v68
    v_dot2c_f32_bf16 v88, v122, v67
    v_dot2c_f32_bf16 v89, v122, v68
    v_dot2c_f32_bf16 v90, v123, v67
    v_dot2c_f32_bf16 v91, v123, v68
    s_waitcnt vmcnt(14)
    v_dot2c_f32_bf16 v84, v124, v67
    v_dot2c_f32_bf16 v85, v124, v68
    v_dot2c_f32_bf16 v86, v125, v67
    v_dot2c_f32_bf16 v87, v125, v68
    v_dot2c_f32_bf16 v88, v126, v67
    v_dot2c_f32_bf16 v89, v126, v68
    v_dot2c_f32_bf16 v90, v127, v67
    v_dot2c_f32_bf16 v91, v127, v68
    s_waitcnt vmcnt(13)
    v_dot2c_f32_bf16 v84, v128, v67
    v_dot2c_f32_bf16 v85, v128, v68
    v_dot2c_f32_bf16 v86, v129, v67
    v_dot2c_f32_bf16 v87, v129, v68
    v_dot2c_f32_bf16 v88, v130, v67
    v_dot2c_f32_bf16 v89, v130, v68
    v_dot2c_f32_bf16 v90, v131, v67
    v_dot2c_f32_bf16 v91, v131, v68
    s_waitcnt vmcnt(12)
    v_dot2c_f32_bf16 v84, v132, v67
    v_dot2c_f32_bf16 v85, v132, v68
    v_dot2c_f32_bf16 v86, v133, v67
    v_dot2c_f32_bf16 v87, v133, v68
    v_dot2c_f32_bf16 v88, v134, v67
    v_dot2c_f32_bf16 v89, v134, v68
    v_dot2c_f32_bf16 v90, v135, v67
    v_dot2c_f32_bf16 v91, v135, v68
    s_waitcnt vmcnt(11)
    v_dot2c_f32_bf16 v84, v136, v67
    v_dot2c_f32_bf16 v85, v136, v68
    v_dot2c_f32_bf16 v86, v137, v67
    v_dot2c_f32_bf16 v87, v137, v68
    v_dot2c_f32_bf16 v88, v138, v67
    v_dot2c_f32_bf16 v89, v138, v68
    v_dot2c_f32_bf16 v90, v139, v67
    v_dot2c_f32_bf16 v91, v139, v68
    s_waitcnt vmcnt(10)
    v_dot2c_f32_bf16 v84, v140, v67
    v_dot2c_f32_bf16 v85, v140, v68
    v_dot2c_f32_bf16 v86, v141, v67
    v_dot2c_f32_bf16 v87, v141, v68
    v_dot2c_f32_bf16 v88, v142, v67
    v_dot2c_f32_bf16 v89, v142, v68
    v_dot2c_f32_bf16 v90, v143, v67
    v_dot2c_f32_bf16 v91, v143, v68
    s_waitcnt vmcnt(9)
    v_dot2c_f32_bf16 v84, v144, v67
    v_dot2c_f32_bf16 v85, v144, v68
    v_dot2c_f32_bf16 v86, v145, v67
    v_dot2c_f32_bf16 v87, v145, v68
    v_dot2c_f32_bf16 v88, v146, v67
    v_dot2c_f32_bf16 v89, v146, v68
    v_dot2c_f32_bf16 v90, v147, v67
    v_dot2c_f32_bf16 v91, v147, v68
    s_waitcnt vmcnt(8)
    v_dot2c_f32_bf16 v84, v148, v67
    v_dot2c_f32_bf16 v85, v148, v68
    v_dot2c_f32_bf16 v86, v149, v67
    v_dot2c_f32_bf16 v87, v149, v68
    v_dot2c_f32_bf16 v88, v150, v67
    v_dot2c_f32_bf16 v89, v150, v68
    v_dot2c_f32_bf16 v90, v151, v67
    v_dot2c_f32_bf16 v91, v151, v68
    s_waitcnt vmcnt(7)
    v_dot2c_f32_bf16 v84, v152, v67
    v_dot2c_f32_bf16 v85, v152, v68
    v_dot2c_f32_bf16 v86, v153, v67
    v_dot2c_f32_bf16 v87, v153, v68
    v_dot2c_f32_bf16 v88, v154, v67
    v_dot2c_f32_bf16 v89, v154, v68
    v_dot2c_f32_bf16 v90, v155, v67
    v_dot2c_f32_bf16 v91, v155, v68
    s_waitcnt vmcnt(6)
    v_dot2c_f32_bf16 v84, v156, v67
    v_dot2c_f32_bf16 v85, v156, v68
    v_dot2c_f32_bf16 v86, v157, v67
    v_dot2c_f32_bf16 v87, v157, v68
    v_dot2c_f32_bf16 v88, v158, v67
    v_dot2c_f32_bf16 v89, v158, v68
    v_dot2c_f32_bf16 v90, v159, v67
    v_dot2c_f32_bf16 v91, v159, v68
    v_cvt_pk_bf16_f32 v176, v84, v85
    v_cvt_pk_bf16_f32 v177, v86, v87
    v_cvt_pk_bf16_f32 v178, v88, v89
    v_cvt_pk_bf16_f32 v179, v90, v91
    ds_write_b128 v57, v[176:179]
    s_waitcnt lgkmcnt(0)
    s_barrier
    ds_read_b128 v[160:163], v58 offset:0
    ds_read_b128 v[164:167], v58 offset:1024
    ds_read_b128 v[168:171], v58 offset:2048
    ds_read_b128 v[172:175], v58 offset:3072
    s_waitcnt lgkmcnt(3)
    v_mfma_f32_32x32x16_bf16 v[208:223], v[160:163], v[28:31], 0
    s_waitcnt lgkmcnt(2)
    v_mfma_f32_32x32x16_bf16 v[208:223], v[164:167], v[32:35], v[208:223]
    s_waitcnt lgkmcnt(1)
    v_mfma_f32_32x32x16_bf16 v[208:223], v[168:171], v[36:39], v[208:223]
    s_waitcnt lgkmcnt(0)
    v_mfma_f32_32x32x16_bf16 v[208:223], v[172:175], v[40:43], v[208:223]
    s_nop 11
    v_mov_b32 v2, v220
    v_mov_b32 v3, v220
    s_nop 1
    v_permlane32_swap_b32_e64 v2, v3
    v_add_f32 v3, 0x358637bd, v3
    v_rcp_f32 v72, v3
    s_nop 0
    v_pk_mul_f32 v[208:209], v[208:209], v[72:73] op_sel_hi:[1,0]
    v_pk_mul_f32 v[210:211], v[210:211], v[72:73] op_sel_hi:[1,0]
    v_pk_mul_f32 v[212:213], v[212:213], v[72:73] op_sel_hi:[1,0]
    v_pk_mul_f32 v[214:215], v[214:215], v[72:73] op_sel_hi:[1,0]
    v_pk_mul_f32 v[216:217], v[216:217], v[72:73] op_sel_hi:[1,0]
    v_pk_mul_f32 v[218:219], v[218:219], v[72:73] op_sel_hi:[1,0]
    v_pk_mul_f32 v[220:221], v[220:221], v[72:73] op_sel_hi:[1,0]
    v_pk_mul_f32 v[222:223], v[222:223], v[72:73] op_sel_hi:[1,0]
    v_cvt_pk_bf16_f32 v176, v208, v209
    v_cvt_pk_bf16_f32 v177, v210, v211
    v_cvt_pk_bf16_f32 v178, v212, v213
    v_cvt_pk_bf16_f32 v179, v214, v215
    buffer_store_dwordx4 v[176:179], v6, s[60:63], s15 offen sc1
    v_cvt_pk_bf16_f32 v180, v216, v217
    v_cvt_pk_bf16_f32 v181, v218, v219
    v_cvt_pk_bf16_f32 v182, v220, v221
    v_cvt_pk_bf16_f32 v183, v222, v223
    s_mov_b32 exec_lo, 0
    s_mov_b32 exec_hi, -1
    v_mov_b32_e64 v182, 0
    v_mov_b32 v183, 0
    s_mov_b64 exec, -1
    buffer_store_dwordx4 v[180:183], v6, s[60:63], s15 offen offset:1024 sc1
    ds_read_b64_tr_b16 a[128:129], v55 offset:0
    s_add_u32 m0, s26, 0
    s_add_u32 s92, s35, 0
    buffer_load_dwordx4 v19, s[64:67], s92 offen offset:0 lds
    ds_read_b64_tr_b16 a[130:131], v55 offset:1024
    ds_read_b64_tr_b16 a[132:133], v56 offset:0
    ds_read_b64_tr_b16 a[134:135], v56 offset:1024
    ds_read_b64_tr_b16 a[136:137], v55 offset:2048
    ds_read_b64_tr_b16 a[138:139], v55 offset:3072
    buffer_load_dwordx4 v20, s[64:67], s92 offen offset:1024 lds
    ds_read_b64_tr_b16 a[140:141], v56 offset:2048
    ds_read_b64_tr_b16 a[142:143], v56 offset:3072
    ds_read_b64_tr_b16 a[144:145], v55 offset:3584
    ds_read_b64_tr_b16 a[146:147], v55 offset:4608
    ds_read_b64_tr_b16 a[148:149], v56 offset:3584
    buffer_load_dwordx4 v21, s[64:67], s92 offen offset:2048 lds
    ds_read_b64_tr_b16 a[150:151], v56 offset:4608
    ds_read_b64_tr_b16 a[152:153], v55 offset:5632
    ds_read_b64_tr_b16 a[154:155], v55 offset:6656
    ds_read_b64_tr_b16 a[156:157], v56 offset:5632
    ds_read_b64_tr_b16 a[158:159], v56 offset:6656
    buffer_load_dwordx4 v22, s[64:67], s92 offen offset:3072 lds
    ds_read_b64_tr_b16 a[160:161], v55 offset:10752
    ds_read_b64_tr_b16 a[162:163], v55 offset:11776
    ds_read_b64_tr_b16 a[164:165], v56 offset:10752
    ds_read_b64_tr_b16 a[166:167], v56 offset:11776
    ds_read_b64_tr_b16 a[168:169], v55 offset:12800
    s_add_u32 m0, s26, 16384
    s_add_u32 s92, s35, 458752
    buffer_load_dwordx4 v19, s[64:67], s92 offen offset:0 lds
    ds_read_b64_tr_b16 a[170:171], v55 offset:13824
    ds_read_b64_tr_b16 a[172:173], v56 offset:12800
    ds_read_b64_tr_b16 a[174:175], v56 offset:13824
    ds_read_b64_tr_b16 a[176:177], v55 offset:17920
    ds_read_b64_tr_b16 a[178:179], v55 offset:18944
    buffer_load_dwordx4 v20, s[64:67], s92 offen offset:1024 lds
    ds_read_b64_tr_b16 a[180:181], v56 offset:17920
    ds_read_b64_tr_b16 a[182:183], v56 offset:18944
    ds_read_b64_tr_b16 a[184:185], v55 offset:19968
    ds_read_b64_tr_b16 a[186:187], v55 offset:20992
    ds_read_b64_tr_b16 a[188:189], v56 offset:19968
    buffer_load_dwordx4 v21, s[64:67], s92 offen offset:2048 lds
    ds_read_b64_tr_b16 a[190:191], v56 offset:20992
    ds_read_b64_tr_b16 a[192:193], v63 offset:50176
    ds_read_b64_tr_b16 a[194:195], v63 offset:51200
    ds_read_b64_tr_b16 a[196:197], v64 offset:50176
    ds_read_b64_tr_b16 a[198:199], v64 offset:51200
    buffer_load_dwordx4 v22, s[64:67], s92 offen offset:3072 lds
    ds_read_b64_tr_b16 a[200:201], v63 offset:52224
    ds_read_b64_tr_b16 a[202:203], v63 offset:53248
    ds_read_b64_tr_b16 a[204:205], v64 offset:52224
    ds_read_b64_tr_b16 a[206:207], v64 offset:53248
    ds_read_b64_tr_b16 a[208:209], v55 offset:7168
    s_add_u32 m0, s26, 32768
    s_add_u32 s92, s35, 917504
    buffer_load_dwordx4 v19, s[64:67], s92 offen offset:0 lds
    ds_read_b64_tr_b16 a[210:211], v55 offset:8192
    ds_read_b64_tr_b16 a[212:213], v56 offset:7168
    ds_read_b64_tr_b16 a[214:215], v56 offset:8192
    ds_read_b64_tr_b16 a[216:217], v55 offset:9216
    ds_read_b64_tr_b16 a[218:219], v55 offset:10240
    buffer_load_dwordx4 v20, s[64:67], s92 offen offset:1024 lds
    ds_read_b64_tr_b16 a[220:221], v56 offset:9216
    ds_read_b64_tr_b16 a[222:223], v56 offset:10240
    ds_read_b64_tr_b16 a[224:225], v55 offset:14336
    ds_read_b64_tr_b16 a[226:227], v55 offset:15360
    ds_read_b64_tr_b16 a[228:229], v56 offset:14336
    buffer_load_dwordx4 v21, s[64:67], s92 offen offset:2048 lds
    ds_read_b64_tr_b16 a[230:231], v56 offset:15360
    ds_read_b64_tr_b16 a[232:233], v55 offset:16384
    ds_read_b64_tr_b16 a[234:235], v55 offset:17408
    ds_read_b64_tr_b16 a[236:237], v56 offset:16384
    ds_read_b64_tr_b16 a[238:239], v56 offset:17408
    buffer_load_dwordx4 v22, s[64:67], s92 offen offset:3072 lds
    ds_read_b64_tr_b16 a[240:241], v55 offset:21504
    ds_read_b64_tr_b16 a[242:243], v55 offset:22528
    ds_read_b64_tr_b16 a[244:245], v56 offset:21504
    ds_read_b64_tr_b16 a[246:247], v56 offset:22528
    ds_read_b64_tr_b16 a[248:249], v55 offset:23552
    ds_read_b64_tr_b16 a[250:251], v55 offset:24576
    ds_read_b64_tr_b16 a[252:253], v56 offset:23552
    ds_read_b64_tr_b16 a[254:255], v56 offset:24576
    s_waitcnt vmcnt(12) lgkmcnt(0)
    s_barrier
    buffer_store_dword v7, v10, s[60:63], s38 offen sc1
    s_cmp_ge_u32 s3, 28
    s_cbranch_scc1 L_idle
    s_lshl_b32 s14, s19, 15
    s_add_u32 m0, s17, 49152
    s_add_u32 s92, s36, 1376256
    buffer_load_dwordx4 v19, s[64:67], s92 offen offset:0 lds
    s_and_b32 s12, s4, 1
    s_add_u32 s14, s14, 2097152
    s_lshl_b32 s15, s12, 11
    s_add_u32 s15, s15, s14
    s_mul_i32 s12, s12, 14336
    s_add_u32 s14, s14, s12
    buffer_load_dwordx4 v20, s[64:67], s92 offen offset:1024 lds
    s_add_u32 m0, s26, 57344
    s_add_u32 s92, s35, 128
    buffer_load_dwordx4 v19, s[64:67], s92 offen offset:0 lds
    buffer_load_dwordx4 v20, s[64:67], s92 offen offset:1024 lds
    buffer_load_dwordx4 v21, s[64:67], s92 offen offset:2048 lds
    buffer_load_dwordx4 v22, s[64:67], s92 offen offset:3072 lds
    s_load_dwordx16 s[44:59], s[0:1], s28 glc
    s_mov_b32 s13, 0
    s_waitcnt lgkmcnt(0)
    s_xor_b64 s[44:45], s[44:45], s[22:23]
    s_xor_b64 s[46:47], s[46:47], s[22:23]
    s_xor_b64 s[48:49], s[48:49], s[22:23]
    s_xor_b64 s[50:51], s[50:51], s[22:23]
    s_xor_b64 s[52:53], s[52:53], s[22:23]
    s_or_b64 s[44:45], s[44:45], s[46:47]
    s_or_b64 s[44:45], s[44:45], s[48:49]
    s_or_b64 s[44:45], s[44:45], s[50:51]
    s_or_b64 s[44:45], s[44:45], s[52:53]
    s_cbranch_scc1 L_sp1
L_sp1_done:
    s_load_dwordx16 s[44:59], s[0:1], s27 glc
    s_add_u32 s99, s14, 0
    buffer_load_dwordx4 v[56:59], v6, s[60:63], s99 offen offset:0 sc1
    buffer_load_dwordx4 v[60:63], v6, s[60:63], s99 offen offset:1024 sc1
    s_add_u32 s99, s14, 2048
    buffer_load_dwordx4 v[64:67], v6, s[60:63], s99 offen offset:0 sc1
    buffer_load_dwordx4 v[68:71], v6, s[60:63], s99 offen offset:1024 sc1
    s_add_u32 s99, s14, 6144
    buffer_load_dwordx4 v[72:75], v6, s[60:63], s99 offen offset:0 sc1
    buffer_load_dwordx4 v[76:79], v6, s[60:63], s99 offen offset:1024 sc1
    s_lshl_b32 s13, s8, 7
    s_add_u32 s99, s14, 10240
    buffer_load_dwordx4 v[80:83], v6, s[60:63], s99 offen offset:0 sc1
    s_lshr_b32 s30, s4, 1
    s_lshl_b32 s30, s30, 3
    s_and_b32 s29, s4, 1
    s_add_u32 s30, s30, s29
    s_mul_i32 s29, s30, 14336
    s_add_u32 s29, s29, s13
    v_add_u32 v15, s29, v15
    buffer_load_dwordx4 v[84:87], v6, s[60:63], s99 offen offset:1024 sc1
    v_add_u32 v16, s29, v16
    v_xor_b32 v3, 64, v46
    s_add_u32 s12, s17, 0
    v_add_u32 v48, s12, v46
    v_add_u32 v49, s12, v3
    s_add_u32 s12, s17, 65536
    v_add_u32_e64 v50, s12, v46
    s_add_u32 s99, s15, 28672
    buffer_load_dwordx4 v[88:91], v6, s[60:63], s99 offen offset:0 sc1
    v_add_u32_e64 v51, s12, v3
    s_add_u32 s12, s17, 131072
    v_add_u32 v52, s12, v46
    v_add_u32 v53, s12, v3
    s_lshr_b32 s12, s4, 1
    s_mul_i32 s12, s12, 28672
    v_add_u32 v46, s12, v46
    buffer_load_dwordx4 v[92:95], v6, s[60:63], s99 offen offset:1024 sc1
    v_mov_b32 v44, 0
    v_mov_b32 v45, 0
    v_accvgpr_read_b32 v173, a96
    v_accvgpr_read_b32 v175, a97
    v_accvgpr_read_b32 v177, a98
    v_accvgpr_read_b32 v179, a99
    v_accvgpr_read_b32 v181, a100
    v_accvgpr_read_b32 v183, a101
    v_accvgpr_read_b32 v185, a102
    v_accvgpr_read_b32 v187, a103
    v_permlane32_swap_b32 v173, v177
    v_permlane32_swap_b32 v175, v179
    v_permlane32_swap_b32 v181, v185
    v_permlane32_swap_b32 v183, v187
    v_lshlrev_b32 v172, 16, v173
    v_and_b32 v173, 0xffff0000, v173
    v_lshlrev_b32 v174, 16, v175
    v_and_b32 v175, 0xffff0000, v175
    v_lshlrev_b32 v176, 16, v177
    v_and_b32 v177, 0xffff0000, v177
    v_lshlrev_b32 v178, 16, v179
    v_and_b32 v179, 0xffff0000, v179
    v_lshlrev_b32 v180, 16, v181
    v_and_b32 v181, 0xffff0000, v181
    v_lshlrev_b32 v182, 16, v183
    v_and_b32 v183, 0xffff0000, v183
    v_lshlrev_b32 v184, 16, v185
    v_and_b32 v185, 0xffff0000, v185
    v_lshlrev_b32 v186, 16, v187
    v_and_b32 v187, 0xffff0000, v187
    s_mov_b32 s13, 0
    s_waitcnt lgkmcnt(0)
    s_xor_b64 s[44:45], s[44:45], s[22:23]
    s_xor_b64 s[46:47], s[46:47], s[22:23]
    s_xor_b64 s[48:49], s[48:49], s[22:23]
    s_or_b64 s[44:45], s[44:45], s[46:47]
    s_or_b64 s[44:45], s[44:45], s[48:49]
    s_cbranch_scc1 L_sp3
L_sp3_done:
    s_add_u32 s99, s14, 4096
    buffer_load_dwordx4 v[96:99], v6, s[60:63], s99 offen offset:0 sc1
    buffer_load_dwordx4 v[100:103], v6, s[60:63], s99 offen offset:1024 sc1
    s_add_u32 s99, s14, 8192
    buffer_load_dwordx4 v[104:107], v6, s[60:63], s99 offen offset:0 sc1
    buffer_load_dwordx4 v[108:111], v6, s[60:63], s99 offen offset:1024 sc1
    s_add_u32 s99, s14, 12288
    buffer_load_dwordx4 v[112:115], v6, s[60:63], s99 offen offset:0 sc1
    buffer_load_dwordx4 v[116:119], v6, s[60:63], s99 offen offset:1024 sc1
    s_waitcnt vmcnt(15)
    v_mfma_f32_32x32x16_bf16 v[136:151], a[132:135], v[56:59], 0
    s_add_u32 m0, s26, 73728
    s_add_u32 s92, s35, 458880
    buffer_load_dwordx4 v19, s[64:67], s92 offen offset:0 lds
    v_mfma_f32_32x32x16_bf16 v[120:135], a[128:131], v[56:59], v[172:187]
    v_mov_b32 v168, 0
    v_mov_b32 v169, 0
    s_waitcnt vmcnt(15)
    v_mfma_f32_32x32x16_bf16 v[136:151], a[140:143], v[60:63], v[136:151]
    buffer_load_dwordx4 v20, s[64:67], s92 offen offset:1024 lds
    v_mfma_f32_32x32x16_bf16 v[120:135], a[136:139], v[60:63], v[120:135]
    buffer_store_dword v168, v23, s[80:83], 0 offen sc1
    s_add_u32 s12, s26, 147456
    s_waitcnt vmcnt(16)
    v_mfma_f32_32x32x16_bf16 v[136:151], a[148:151], v[64:67], v[136:151]
    buffer_load_dwordx4 v21, s[64:67], s92 offen offset:2048 lds
    v_add_u32 v2, s12, v6
    v_mfma_f32_32x32x16_bf16 v[120:135], a[144:147], v[64:67], v[120:135]
    v_xor_b32 v3, 4096, v2
    s_mul_i32 s12, s19, 28672
    s_lshl_b32 s13, s20, 11
    s_add_u32 s12, s12, s13
    s_add_u32 s12, s12, 4194304
    s_lshl_b32 s14, s19, 12
    s_waitcnt vmcnt(16)
    v_mfma_f32_32x32x16_bf16 v[136:151], a[156:159], v[68:71], v[136:151]
    buffer_load_dwordx4 v22, s[64:67], s92 offen offset:3072 lds
    s_lshl_b32 s13, s20, 8
    v_mfma_f32_32x32x16_bf16 v[120:135], a[152:155], v[68:71], v[120:135]
    s_add_u32 s14, s14, s13
    s_add_u32 s14, s14, 1572864
    v_and_b32 v4, 31, v1
    v_lshlrev_b32 v4, 3, v4
    v_lshl_add_u32 v4, v13, 2, v4
    s_waitcnt vmcnt(16)
    v_mfma_f32_32x32x16_bf16 v[136:151], a[164:167], v[72:75], v[136:151]
    s_add_u32 m0, s26, 90112
    s_add_u32 s92, s35, 917632
    buffer_load_dwordx4 v19, s[64:67], s92 offen offset:0 lds
    v_mfma_f32_32x32x16_bf16 v[120:135], a[160:163], v[72:75], v[120:135]
    s_waitcnt vmcnt(16)
    v_mfma_f32_32x32x16_bf16 v[136:151], a[172:175], v[76:79], v[136:151]
    buffer_load_dwordx4 v20, s[64:67], s92 offen offset:1024 lds
    v_mfma_f32_32x32x16_bf16 v[120:135], a[168:171], v[76:79], v[120:135]
    s_waitcnt vmcnt(16)
    v_mfma_f32_32x32x16_bf16 v[136:151], a[180:183], v[80:83], v[136:151]
    buffer_load_dwordx4 v21, s[64:67], s92 offen offset:2048 lds
    v_mfma_f32_32x32x16_bf16 v[120:135], a[176:179], v[80:83], v[120:135]
    s_waitcnt vmcnt(16)
    v_mfma_f32_32x32x16_bf16 v[136:151], a[188:191], v[84:87], v[136:151]
    buffer_load_dwordx4 v22, s[64:67], s92 offen offset:3072 lds
    v_mfma_f32_32x32x16_bf16 v[120:135], a[184:187], v[84:87], v[120:135]
    s_waitcnt vmcnt(16)
    v_mfma_f32_32x32x16_bf16 v[136:151], a[196:199], v[88:91], v[136:151]
    s_add_u32 m0, s17, 106496
    s_add_u32 s92, s36, 1376384
    buffer_load_dwordx4 v19, s[64:67], s92 offen offset:0 lds
    v_mfma_f32_32x32x16_bf16 v[120:135], a[192:195], v[88:91], v[120:135]
    s_waitcnt vmcnt(16)
    v_mfma_f32_32x32x16_bf16 v[136:151], a[204:207], v[92:95], v[136:151]
    buffer_load_dwordx4 v20, s[64:67], s92 offen offset:1024 lds
    v_mfma_f32_32x32x16_bf16 v[120:135], a[200:203], v[92:95], v[120:135]
    s_waitcnt vmcnt(16)
    v_mfma_f32_32x32x16_bf16 v[136:151], a[212:215], v[96:99], v[136:151]
    v_mfma_f32_32x32x16_bf16 v[120:135], a[208:211], v[96:99], v[120:135]
    s_waitcnt vmcnt(15)
    v_mfma_f32_32x32x16_bf16 v[136:151], a[220:223], v[100:103], v[136:151]
    v_mfma_f32_32x32x16_bf16 v[120:135], a[216:219], v[100:103], v[120:135]
    s_waitcnt vmcnt(14)
    v_mfma_f32_32x32x16_bf16 v[136:151], a[228:231], v[104:107], v[136:151]
    s_waitcnt vmcnt(13)
    v_mfma_f32_32x32x16_bf16 v[136:151], a[236:239], v[108:111], v[136:151]
    s_waitcnt vmcnt(12)
    v_mfma_f32_32x32x16_bf16 v[136:151], a[244:247], v[112:115], v[136:151]
    s_waitcnt vmcnt(11)
    v_mfma_f32_32x32x16_bf16 v[136:151], a[252:255], v[116:119], v[136:151]
    v_mfma_f32_32x32x16_bf16 v[120:135], a[224:227], v[104:107], v[120:135]
    s_nop 10
    ds_write_b128 v2, v[136:139] offset:0
    v_mfma_f32_32x32x16_bf16 v[120:135], a[232:235], v[108:111], v[120:135]
    ds_write_b128 v2, v[140:143] offset:1024
    v_mfma_f32_32x32x16_bf16 v[120:135], a[240:243], v[112:115], v[120:135]
    ds_write_b128 v2, v[144:147] offset:2048
    v_mfma_f32_32x32x16_bf16 v[120:135], a[248:251], v[116:119], v[120:135]
    ds_write_b128 v2, v[148:151] offset:3072
    s_waitcnt lgkmcnt(0)
    s_barrier
    ds_read_b128 v[152:155], v3 offset:0
    ds_read_b128 v[156:159], v3 offset:1024
    ds_read_b128 v[160:163], v3 offset:2048
    ds_read_b128 v[164:167], v3 offset:3072
    s_waitcnt lgkmcnt(3)
    s_nop 3
    v_pk_add_f32 v[152:153], v[152:153], v[120:121]
    v_pk_add_f32 v[154:155], v[154:155], v[122:123]
    s_waitcnt lgkmcnt(2)
    v_pk_add_f32 v[156:157], v[156:157], v[124:125]
    v_pk_add_f32 v[158:159], v[158:159], v[126:127]
    v_cvt_pk_bf16_f32 v36, v152, v153
    v_cvt_pk_bf16_f32 v37, v154, v155
    v_cvt_pk_bf16_f32 v38, v156, v157
    v_cvt_pk_bf16_f32 v39, v158, v159
    buffer_store_dwordx4 v[36:39], v6, s[60:63], s12 offen offset:0 sc1
    s_waitcnt lgkmcnt(1)
    v_pk_add_f32 v[160:161], v[160:161], v[128:129]
    v_pk_add_f32 v[162:163], v[162:163], v[130:131]
    s_waitcnt lgkmcnt(0)
    v_pk_add_f32 v[164:165], v[164:165], v[132:133]
    v_pk_add_f32 v[166:167], v[166:167], v[134:135]
    v_cvt_pk_bf16_f32 v40, v160, v161
    v_cvt_pk_bf16_f32 v41, v162, v163
    v_cvt_pk_bf16_f32 v42, v164, v165
    v_cvt_pk_bf16_f32 v43, v166, v167
    buffer_store_dwordx4 v[40:43], v6, s[60:63], s12 offen offset:1024 sc1
    v_dot2c_f32_bf16 v168, v36, v14
    v_dot2c_f32_bf16 v169, v36, v36
    v_dot2c_f32_bf16 v168, v37, v14
    v_dot2c_f32_bf16 v169, v37, v37
    v_dot2c_f32_bf16 v168, v38, v14
    v_dot2c_f32_bf16 v169, v38, v38
    v_dot2c_f32_bf16 v168, v39, v14
    v_dot2c_f32_bf16 v169, v39, v39
    v_dot2c_f32_bf16 v168, v40, v14
    v_dot2c_f32_bf16 v169, v40, v40
    v_dot2c_f32_bf16 v168, v41, v14
    v_dot2c_f32_bf16 v169, v41, v41
    v_dot2c_f32_bf16 v168, v42, v14
    v_dot2c_f32_bf16 v169, v42, v42
    v_dot2c_f32_bf16 v168, v43, v14
    v_dot2c_f32_bf16 v169, v43, v43
    s_nop 2
    v_permlane32_swap_b32 v168, v169
    v_add_f32 v168, v168, v169
    buffer_store_dword v168, v4, s[60:63], s14 offen sc1
    v_mov_b32 v54, v47
    v_xor_b32_e64 v55, 64, v47
    v_add_u32 v56, 57344, v54
    v_add_u32 v57, 57344, v55
    v_lshlrev_b32 v58, 3, v1
    v_accvgpr_read_b32 v74, a112
    v_accvgpr_read_b32 v78, a113
    v_accvgpr_read_b32 v82, a114
    v_accvgpr_read_b32 v86, a115
    v_accvgpr_read_b32 v216, a104
    v_accvgpr_read_b32 v217, a105
    v_accvgpr_read_b32 v218, a106
    v_accvgpr_read_b32 v219, a107
    v_accvgpr_read_b32 v220, a108
    v_accvgpr_read_b32 v221, a109
    v_accvgpr_read_b32 v222, a110
    v_accvgpr_read_b32 v223, a111
    ds_read_b64_tr_b16 v[152:153], v46 offset:0
    s_add_u32 m0, s17, 114688
    s_mov_b32 s92, 0
    buffer_load_dwordx4 v15, s[68:71], s92 offen lds
    ds_read_b64_tr_b16 v[154:155], v46 offset:1024
    ds_read_b64_tr_b16 v[156:157], v46 offset:2048
    ds_read_b64_tr_b16 v[158:159], v46 offset:3072
    ds_read_b64_tr_b16 v[160:161], v46 offset:4096
    ds_read_b64_tr_b16 v[162:163], v46 offset:5120
    ds_read_b64_tr_b16 v[164:165], v46 offset:6144
    ds_read_b64_tr_b16 v[166:167], v46 offset:7168
    ds_read_b64_tr_b16 v[168:169], v46 offset:8192
    buffer_load_dwordx4 v16, s[68:71], s92 offen offset:1024 lds
    ds_read_b64_tr_b16 v[170:171], v46 offset:9216
    ds_read_b64_tr_b16 v[172:173], v46 offset:10240
    ds_read_b64_tr_b16 v[174:175], v46 offset:11264
    ds_read_b64_tr_b16 v[176:177], v46 offset:12288
    ds_read_b64_tr_b16 v[178:179], v46 offset:13312
    ds_read_b64_tr_b16 v[180:181], v46 offset:14336
    ds_read_b64_tr_b16 v[182:183], v46 offset:15360
    s_waitcnt lgkmcnt(15)
    v_dot2c_f32_bf16 v44, v152, v14
    v_dot2c_f32_bf16 v44, v153, v14
    s_waitcnt lgkmcnt(14)
    v_dot2c_f32_bf16 v44, v154, v14
    s_add_u32 m0, s17, 122880
    s_mov_b32 s92, 229376
    buffer_load_dwordx4 v15, s[68:71], s92 offen lds
    v_dot2c_f32_bf16 v44, v155, v14
    s_waitcnt lgkmcnt(13)
    v_dot2c_f32_bf16 v44, v156, v14
    v_dot2c_f32_bf16 v44, v157, v14
    s_waitcnt lgkmcnt(12)
    v_dot2c_f32_bf16 v44, v158, v14
    v_dot2c_f32_bf16 v44, v159, v14
    s_waitcnt lgkmcnt(11)
    v_dot2c_f32_bf16 v44, v160, v14
    v_dot2c_f32_bf16 v44, v161, v14
    s_waitcnt lgkmcnt(10)
    v_dot2c_f32_bf16 v44, v162, v14
    buffer_load_dwordx4 v16, s[68:71], s92 offen offset:1024 lds
    v_dot2c_f32_bf16 v44, v163, v14
    s_waitcnt lgkmcnt(9)
    v_dot2c_f32_bf16 v44, v164, v14
    v_dot2c_f32_bf16 v44, v165, v14
    s_waitcnt lgkmcnt(8)
    v_dot2c_f32_bf16 v44, v166, v14
    v_dot2c_f32_bf16 v44, v167, v14
    ds_read_b64_tr_b16 v[152:153], v46 offset:16384
    ds_read_b64_tr_b16 v[154:155], v46 offset:17408
    ds_read_b64_tr_b16 v[156:157], v46 offset:18432
    ds_read_b64_tr_b16 v[158:159], v46 offset:19456
    ds_read_b64_tr_b16 v[160:161], v46 offset:20480
    ds_read_b64_tr_b16 v[162:163], v46 offset:21504
    ds_read_b64_tr_b16 v[164:165], v46 offset:22528
    ds_read_b64_tr_b16 v[166:167], v46 offset:23552
    s_waitcnt lgkmcnt(15)
    v_dot2c_f32_bf16 v44, v168, v14
    v_dot2c_f32_bf16 v44, v169, v14
    s_waitcnt lgkmcnt(14)
    v_dot2c_f32_bf16 v44, v170, v14
    v_dot2c_f32_bf16 v44, v171, v14
    s_waitcnt lgkmcnt(13)
    v_dot2c_f32_bf16 v44, v172, v14
    v_dot2c_f32_bf16 v44, v173, v14
    s_waitcnt lgkmcnt(12)
    v_dot2c_f32_bf16 v44, v174, v14
    v_dot2c_f32_bf16 v44, v175, v14
    s_waitcnt lgkmcnt(11)
    v_dot2c_f32_bf16 v44, v176, v14
    v_dot2c_f32_bf16 v44, v177, v14
    s_waitcnt lgkmcnt(10)
    v_dot2c_f32_bf16 v44, v178, v14
    v_dot2c_f32_bf16 v44, v179, v14
    s_waitcnt lgkmcnt(9)
    v_dot2c_f32_bf16 v44, v180, v14
    v_dot2c_f32_bf16 v44, v181, v14
    s_waitcnt lgkmcnt(8)
    v_dot2c_f32_bf16 v44, v182, v14
    v_dot2c_f32_bf16 v44, v183, v14
    ds_read_b64_tr_b16 v[168:169], v46 offset:24576
    ds_read_b64_tr_b16 v[170:171], v46 offset:25600
    ds_read_b64_tr_b16 v[172:173], v46 offset:26624
    ds_read_b64_tr_b16 v[174:175], v46 offset:27648
    s_waitcnt lgkmcnt(11)
    v_dot2c_f32_bf16 v44, v152, v14
    v_dot2c_f32_bf16 v44, v153, v14
    s_waitcnt lgkmcnt(10)
    v_dot2c_f32_bf16 v44, v154, v14
    v_dot2c_f32_bf16 v44, v155, v14
    s_waitcnt lgkmcnt(9)
    v_dot2c_f32_bf16 v44, v156, v14
    v_dot2c_f32_bf16 v44, v157, v14
    s_waitcnt lgkmcnt(8)
    v_dot2c_f32_bf16 v44, v158, v14
    v_dot2c_f32_bf16 v44, v159, v14
    s_waitcnt lgkmcnt(7)
    v_dot2c_f32_bf16 v44, v160, v14
    v_dot2c_f32_bf16 v44, v161, v14
    s_waitcnt lgkmcnt(6)
    v_dot2c_f32_bf16 v44, v162, v14
    v_dot2c_f32_bf16 v44, v163, v14
    s_waitcnt lgkmcnt(5)
    v_dot2c_f32_bf16 v44, v164, v14
    v_dot2c_f32_bf16 v44, v165, v14
    s_waitcnt lgkmcnt(4)
    v_dot2c_f32_bf16 v44, v166, v14
    v_dot2c_f32_bf16 v44, v167, v14
    s_waitcnt lgkmcnt(3)
    v_dot2c_f32_bf16 v44, v168, v14
    v_dot2c_f32_bf16 v44, v169, v14
    s_waitcnt lgkmcnt(2)
    v_dot2c_f32_bf16 v44, v170, v14
    v_dot2c_f32_bf16 v44, v171, v14
    s_waitcnt lgkmcnt(1)
    v_dot2c_f32_bf16 v44, v172, v14
    v_dot2c_f32_bf16 v44, v173, v14
    s_waitcnt lgkmcnt(0)
    v_dot2c_f32_bf16 v44, v174, v14
    v_dot2c_f32_bf16 v44, v175, v14
    v_add_u32 v46, 57344, v46
    s_waitcnt vmcnt(4)
    s_barrier
    buffer_store_dword v7, v10, s[60:63], s39 offen sc1
    ds_read_b64_tr_b16 v[152:153], v46 offset:0
    s_add_u32 m0, s17, 131072
    s_mov_b32 s92, 458752
    buffer_load_dwordx4 v15, s[68:71], s92 offen lds
    ds_read_b64_tr_b16 v[154:155], v46 offset:1024
    ds_read_b64_tr_b16 v[156:157], v46 offset:2048
    ds_read_b64_tr_b16 v[158:159], v46 offset:3072
    ds_read_b64_tr_b16 v[160:161], v46 offset:4096
    ds_read_b64_tr_b16 v[162:163], v46 offset:5120
    ds_read_b64_tr_b16 v[164:165], v46 offset:6144
    ds_read_b64_tr_b16 v[166:167], v46 offset:7168
    buffer_load_dwordx4 v16, s[68:71], s92 offen offset:1024 lds
    ds_read_b64_tr_b16 v[168:169], v46 offset:8192
    ds_read_b64_tr_b16 v[170:171], v46 offset:9216
    ds_read_b64_tr_b16 v[172:173], v46 offset:10240
    ds_read_b64_tr_b16 v[174:175], v46 offset:11264
    ds_read_b64_tr_b16 v[176:177], v46 offset:12288
    ds_read_b64_tr_b16 v[178:179], v46 offset:13312
    ds_read_b64_tr_b16 v[180:181], v46 offset:14336
    s_add_u32 m0, s17, 139264
    s_mov_b32 s92, 688128
    buffer_load_dwordx4 v15, s[68:71], s92 offen lds
    ds_read_b64_tr_b16 v[182:183], v46 offset:15360
    s_waitcnt lgkmcnt(15)
    v_dot2c_f32_bf16 v45, v152, v14
    v_dot2c_f32_bf16 v45, v153, v14
    s_waitcnt lgkmcnt(14)
    v_dot2c_f32_bf16 v45, v154, v14
    v_dot2c_f32_bf16 v45, v155, v14
    s_waitcnt lgkmcnt(13)
    v_dot2c_f32_bf16 v45, v156, v14
    v_dot2c_f32_bf16 v45, v157, v14
    buffer_load_dwordx4 v16, s[68:71], s92 offen offset:1024 lds
    s_waitcnt lgkmcnt(12)
    v_dot2c_f32_bf16 v45, v158, v14
    v_dot2c_f32_bf16 v45, v159, v14
    s_waitcnt lgkmcnt(11)
    v_dot2c_f32_bf16 v45, v160, v14
    v_dot2c_f32_bf16 v45, v161, v14
    s_waitcnt lgkmcnt(10)
    v_dot2c_f32_bf16 v45, v162, v14
    v_dot2c_f32_bf16 v45, v163, v14
    s_waitcnt lgkmcnt(9)
    v_dot2c_f32_bf16 v45, v164, v14
    v_dot2c_f32_bf16 v45, v165, v14
    s_waitcnt lgkmcnt(8)
    v_dot2c_f32_bf16 v45, v166, v14
    v_dot2c_f32_bf16 v45, v167, v14
    ds_read_b64_tr_b16 v[152:153], v46 offset:16384
    ds_read_b64_tr_b16 v[154:155], v46 offset:17408
    ds_read_b64_tr_b16 v[156:157], v46 offset:18432
    ds_read_b64_tr_b16 v[158:159], v46 offset:19456
    ds_read_b64_tr_b16 v[160:161], v46 offset:20480
    ds_read_b64_tr_b16 v[162:163], v46 offset:21504
    ds_read_b64_tr_b16 v[164:165], v46 offset:22528
    ds_read_b64_tr_b16 v[166:167], v46 offset:23552
    s_waitcnt lgkmcnt(15)
    v_dot2c_f32_bf16 v45, v168, v14
    v_dot2c_f32_bf16 v45, v169, v14
    s_waitcnt lgkmcnt(14)
    v_dot2c_f32_bf16 v45, v170, v14
    v_dot2c_f32_bf16 v45, v171, v14
    s_waitcnt lgkmcnt(13)
    v_dot2c_f32_bf16 v45, v172, v14
    v_dot2c_f32_bf16 v45, v173, v14
    s_waitcnt lgkmcnt(12)
    v_dot2c_f32_bf16 v45, v174, v14
    v_dot2c_f32_bf16 v45, v175, v14
    s_waitcnt lgkmcnt(11)
    v_dot2c_f32_bf16 v45, v176, v14
    v_dot2c_f32_bf16 v45, v177, v14
    s_waitcnt lgkmcnt(10)
    v_dot2c_f32_bf16 v45, v178, v14
    v_dot2c_f32_bf16 v45, v179, v14
    s_waitcnt lgkmcnt(9)
    v_dot2c_f32_bf16 v45, v180, v14
    v_dot2c_f32_bf16 v45, v181, v14
    s_waitcnt lgkmcnt(8)
    v_dot2c_f32_bf16 v45, v182, v14
    v_dot2c_f32_bf16 v45, v183, v14
    ds_read_b64_tr_b16 v[168:169], v46 offset:24576
    ds_read_b64_tr_b16 v[170:171], v46 offset:25600
    ds_read_b64_tr_b16 v[172:173], v46 offset:26624
    ds_read_b64_tr_b16 v[174:175], v46 offset:27648
    s_waitcnt lgkmcnt(11)
    v_dot2c_f32_bf16 v45, v152, v14
    v_dot2c_f32_bf16 v45, v153, v14
    s_waitcnt lgkmcnt(10)
    v_dot2c_f32_bf16 v45, v154, v14
    v_dot2c_f32_bf16 v45, v155, v14
    s_waitcnt lgkmcnt(9)
    v_dot2c_f32_bf16 v45, v156, v14
    v_dot2c_f32_bf16 v45, v157, v14
    s_waitcnt lgkmcnt(8)
    v_dot2c_f32_bf16 v45, v158, v14
    v_dot2c_f32_bf16 v45, v159, v14
    s_waitcnt lgkmcnt(7)
    v_dot2c_f32_bf16 v45, v160, v14
    v_dot2c_f32_bf16 v45, v161, v14
    s_waitcnt lgkmcnt(6)
    v_dot2c_f32_bf16 v45, v162, v14
    v_dot2c_f32_bf16 v45, v163, v14
    s_waitcnt lgkmcnt(5)
    v_dot2c_f32_bf16 v45, v164, v14
    v_dot2c_f32_bf16 v45, v165, v14
    s_waitcnt lgkmcnt(4)
    v_dot2c_f32_bf16 v45, v166, v14
    v_dot2c_f32_bf16 v45, v167, v14
    s_waitcnt lgkmcnt(3)
    v_dot2c_f32_bf16 v45, v168, v14
    v_dot2c_f32_bf16 v45, v169, v14
    s_waitcnt lgkmcnt(2)
    v_dot2c_f32_bf16 v45, v170, v14
    v_dot2c_f32_bf16 v45, v171, v14
    s_waitcnt lgkmcnt(1)
    v_dot2c_f32_bf16 v45, v172, v14
    v_dot2c_f32_bf16 v45, v173, v14
    s_waitcnt lgkmcnt(0)
    v_dot2c_f32_bf16 v45, v174, v14
    v_dot2c_f32_bf16 v45, v175, v14
    s_lshl_b32 s12, s4, 9
    s_add_u32 s12, s12, 155648
    v_lshl_add_u32 v3, v1, 3, s12
    ds_write_b64 v3, v[44:45]
    s_load_dwordx16 s[44:59], s[0:1], s31 glc
    v_mov_b32 v75, v74
    v_lshl_or_b32 v74, v74, 16, v74
    v_mov_b32_e64 v79, v78
    v_lshl_or_b32 v78, v78, 16, v78
    v_mov_b32 v83, v82
    v_lshl_or_b32 v82, v82, 16, v82
    v_mov_b32 v87, v86
    v_lshl_or_b32 v86, v86, 16, v86
    s_mul_i32 s14, s21, 28672
    s_add_u32 s14, s14, 4194304
    s_lshl_b32 s15, s21, 12
    s_add_u32 s15, s15, 1572864
    s_mul_i32 s33, s21, 28672
    s_lshl_b32 s12, s10, 11
    s_add_u32 s33, s33, s12
    s_add_u32 s33, s33, 6291456
    v_lshlrev_b32 v4, 3, v1
    v_add_u32 v4, 155648, v4
    ds_read_b64_tr_b16 v[152:153], v54 offset:0
    ds_read_b64_tr_b16 v[154:155], v54 offset:1024
    ds_read_b64_tr_b16 v[156:157], v54 offset:2048
    ds_read_b64_tr_b16 v[158:159], v54 offset:3072
    ds_read_b64_tr_b16 v[160:161], v54 offset:4096
    ds_read_b64_tr_b16 v[162:163], v54 offset:5120
    ds_read_b64_tr_b16 v[168:169], v55 offset:0
    ds_read_b64_tr_b16 v[170:171], v55 offset:1024
    ds_read_b64_tr_b16 v[172:173], v55 offset:2048
    ds_read_b64_tr_b16 v[174:175], v55 offset:3072
    ds_read_b64_tr_b16 v[176:177], v55 offset:4096
    ds_read_b64_tr_b16 v[178:179], v55 offset:5120
    s_waitcnt lgkmcnt(0)
    s_barrier
    s_mov_b32 s13, 0
    s_xor_b64 s[44:45], s[44:45], s[22:23]
    s_xor_b64 s[46:47], s[46:47], s[22:23]
    s_xor_b64 s[48:49], s[48:49], s[22:23]
    s_xor_b64 s[50:51], s[50:51], s[22:23]
    s_xor_b64 s[52:53], s[52:53], s[22:23]
    s_xor_b64 s[54:55], s[54:55], s[22:23]
    s_xor_b64 s[56:57], s[56:57], s[22:23]
    s_or_b64 s[44:45], s[44:45], s[46:47]
    s_or_b64 s[44:45], s[44:45], s[48:49]
    s_or_b64 s[44:45], s[44:45], s[50:51]
    s_or_b64 s[44:45], s[44:45], s[52:53]
    s_or_b64 s[44:45], s[44:45], s[54:55]
    s_or_b64 s[44:45], s[44:45], s[56:57]
    s_cbranch_scc1 L_sp2
L_sp2_done:
    buffer_load_dwordx4 a[144:147], v6, s[60:63], s14 offen offset:0 sc1
    buffer_load_dwordx4 a[148:151], v6, s[60:63], s14 offen offset:1024 sc1
    buffer_load_dwordx2 v[184:185], v58, s[60:63], s15 offen offset:0 sc1
    buffer_load_dwordx2 v[186:187], v58, s[60:63], s15 offen offset:512 sc1
    buffer_load_dwordx2 v[188:189], v58, s[60:63], s15 offen offset:1024 sc1
    buffer_load_dwordx2 v[190:191], v58, s[60:63], s15 offen offset:1536 sc1
    ds_read_b64 v[200:201], v4 offset:0
    buffer_load_dwordx2 v[192:193], v58, s[60:63], s15 offen offset:2048 sc1
    ds_read_b64 v[202:203], v4 offset:512
    ds_read_b64 v[204:205], v4 offset:1024
    ds_read_b64 v[206:207], v4 offset:1536
    s_waitcnt vmcnt(14)
    ds_read_b64_tr_b16 a[0:1], v50 offset:49152
    ds_read_b64_tr_b16 a[2:3], v50 offset:50176
    buffer_load_dwordx2 v[194:195], v58, s[60:63], s15 offen offset:2560 sc1
    ds_read_b64_tr_b16 a[4:5], v51 offset:49152
    ds_read_b64_tr_b16 a[6:7], v51 offset:50176
    s_waitcnt vmcnt(13)
    ds_read_b64_tr_b16 a[8:9], v50 offset:57344
    ds_read_b64_tr_b16 a[10:11], v50 offset:58368
    ds_read_b64_tr_b16 a[12:13], v51 offset:57344
    buffer_load_dwordx2 v[196:197], v58, s[60:63], s15 offen offset:3072 sc1
    ds_read_b64_tr_b16 a[14:15], v51 offset:58368
    s_waitcnt vmcnt(11)
    ds_read_b64_tr_b16 a[16:17], v52 offset:0
    ds_read_b64_tr_b16 a[18:19], v52 offset:1024
    ds_read_b64_tr_b16 a[20:21], v53 offset:0
    ds_read_b64_tr_b16 a[22:23], v53 offset:1024
    buffer_load_dwordx4 a[152:155], v6, s[60:63], s14 offen offset:2048 sc1
    s_waitcnt vmcnt(10)
    ds_read_b64_tr_b16 a[24:25], v52 offset:8192
    ds_read_b64_tr_b16 a[26:27], v52 offset:9216
    ds_read_b64_tr_b16 a[28:29], v53 offset:8192
    ds_read_b64_tr_b16 a[30:31], v53 offset:9216
    s_waitcnt lgkmcnt(15)
    v_add_f32 v208, v200, v204
    buffer_load_dwordx4 a[156:159], v6, s[60:63], s14 offen offset:3072 sc1
    s_add_u32 s14, s14, 4096
    v_add_f32 v209, v202, v206
    v_add_f32 v210, v201, v205
    v_add_f32 v211, v203, v207
    v_cvt_pk_bf16_f32 v3, v208, v208
    v_and_b32 v3, 0xffff0000, v3
    buffer_load_dwordx4 a[160:163], v6, s[60:63], s14 offen offset:0 sc1
    v_sub_f32 v3, v208, v3
    v_cvt_pk_bf16_f32 v72, v208, v3
    v_mov_b32 v73, v72
    v_cvt_pk_bf16_f32 v3, v209, v209
    v_and_b32 v3, 0xffff0000, v3
    buffer_load_dwordx4 a[164:167], v6, s[60:63], s14 offen offset:1024 sc1
    v_sub_f32 v3, v209, v3
    v_cvt_pk_bf16_f32 v76, v209, v3
    v_mov_b32 v77, v76
    v_cvt_pk_bf16_f32 v3, v210, v210
    v_and_b32 v3, 0xffff0000, v3
    buffer_load_dwordx4 a[168:171], v6, s[60:63], s14 offen offset:2048 sc1
    v_sub_f32 v3, v210, v3
    v_cvt_pk_bf16_f32 v80, v210, v3
    v_mov_b32 v81, v80
    v_cvt_pk_bf16_f32 v3, v211, v211
    v_and_b32 v3, 0xffff0000, v3
    buffer_load_dwordx4 a[172:175], v6, s[60:63], s14 offen offset:3072 sc1
    s_add_u32 s14, s14, 4096
    v_sub_f32 v3, v211, v3
    v_cvt_pk_bf16_f32 v84, v211, v3
    v_mov_b32 v85, v84
    buffer_load_dwordx4 a[176:179], v6, s[60:63], s14 offen offset:0 sc1
    s_waitcnt vmcnt(15)
    v_mfma_f32_32x32x16_bf16 v[88:103], v[152:155], a[144:147], 0
    ds_read_b64_tr_b16 v[164:165], v54 offset:6144
    ds_read_b64_tr_b16 v[166:167], v54 offset:7168
    buffer_load_dwordx4 a[180:183], v6, s[60:63], s14 offen offset:1024 sc1
    s_waitcnt vmcnt(15)
    v_mfma_f32_32x32x16_bf16 v[88:103], v[156:159], a[148:151], v[88:103]
    ds_read_b64_tr_b16 v[152:153], v54 offset:8192
    ds_read_b64_tr_b16 v[154:155], v54 offset:9216
    buffer_load_dwordx4 a[184:187], v6, s[60:63], s14 offen offset:2048 sc1
    v_mfma_f32_32x32x16_bf16 v[104:119], v[168:171], a[144:147], 0
    ds_read_b64_tr_b16 v[180:181], v55 offset:6144
    ds_read_b64_tr_b16 v[182:183], v55 offset:7168
    s_waitcnt vmcnt(14)
    v_add_f32 v184, v184, v186
    s_waitcnt vmcnt(12)
    v_add_f32 v188, v188, v190
    s_waitcnt vmcnt(10)
    v_add_f32 v192, v192, v194
    v_add_f32 v184, v184, v188
    s_waitcnt vmcnt(8)
    v_mfma_f32_32x32x16_bf16 v[88:103], v[160:163], a[152:155], v[88:103]
    ds_read_b64_tr_b16 v[156:157], v54 offset:10240
    ds_read_b64_tr_b16 v[158:159], v54 offset:11264
    buffer_load_dwordx4 a[188:191], v6, s[60:63], s14 offen offset:3072 sc1
    s_add_u32 s14, s14, 4096
    v_mfma_f32_32x32x16_bf16 v[104:119], v[172:175], a[148:151], v[104:119]
    ds_read_b64_tr_b16 v[168:169], v55 offset:8192
    ds_read_b64_tr_b16 v[170:171], v55 offset:9216
    v_add_f32 v192, v192, v196
    v_add_f32 v184, v184, v192
    v_add_f32 v185, v185, v187
    v_add_f32 v189, v189, v191
    s_waitcnt vmcnt(8) lgkmcnt(8)
    v_mfma_f32_32x32x16_bf16 v[88:103], v[164:167], a[156:159], v[88:103]
    ds_read_b64_tr_b16 v[160:161], v54 offset:12288
    ds_read_b64_tr_b16 v[162:163], v54 offset:13312
    buffer_load_dwordx4 a[192:195], v6, s[60:63], s14 offen offset:0 sc1
    s_waitcnt vmcnt(8) lgkmcnt(8)
    v_mfma_f32_32x32x16_bf16 v[88:103], v[152:155], a[160:163], v[88:103]
    ds_read_b64_tr_b16 v[164:165], v54 offset:14336
    ds_read_b64_tr_b16 v[166:167], v54 offset:15360
    buffer_load_dwordx4 a[196:199], v6, s[60:63], s14 offen offset:1024 sc1
    v_mfma_f32_32x32x16_bf16 v[104:119], v[176:179], a[152:155], v[104:119]
    ds_read_b64_tr_b16 v[172:173], v55 offset:10240
    ds_read_b64_tr_b16 v[174:175], v55 offset:11264
    v_add_f32 v193, v193, v195
    v_add_f32 v185, v185, v189
    v_add_f32 v193, v193, v197
    v_add_f32_e64 v185, v185, v193
    s_waitcnt vmcnt(8) lgkmcnt(8)
    v_mfma_f32_32x32x16_bf16 v[88:103], v[156:159], a[164:167], v[88:103]
    ds_read_b64_tr_b16 v[152:153], v54 offset:16384
    ds_read_b64_tr_b16 v[154:155], v54 offset:17408
    buffer_load_dwordx4 a[200:203], v6, s[60:63], s14 offen offset:2048 sc1
    v_mfma_f32_32x32x16_bf16 v[104:119], v[180:183], a[156:159], v[104:119]
    ds_read_b64_tr_b16 v[176:177], v55 offset:12288
    ds_read_b64_tr_b16 v[178:179], v55 offset:13312
    v_mov_b32_e64 v2, v184
    s_nop 1
    v_permlane32_swap_b32 v184, v2
    v_add_f32 v184, v184, v2
    s_waitcnt vmcnt(8) lgkmcnt(8)
    v_mfma_f32_32x32x16_bf16 v[88:103], v[160:163], a[168:171], v[88:103]
    ds_read_b64_tr_b16 v[156:157], v54 offset:18432
    ds_read_b64_tr_b16 v[158:159], v54 offset:19456
    buffer_load_dwordx4 a[204:207], v6, s[60:63], s14 offen offset:3072 sc1
    s_add_u32 s14, s14, 4096
    v_mfma_f32_32x32x16_bf16 v[104:119], v[168:171], a[160:163], v[104:119]
    ds_read_b64_tr_b16 v[180:181], v55 offset:14336
    ds_read_b64_tr_b16 v[182:183], v55 offset:15360
    v_mov_b32 v3, v185
    s_nop 1
    v_permlane32_swap_b32 v185, v3
    v_add_f32 v185, v185, v3
    s_waitcnt vmcnt(8) lgkmcnt(10)
    v_mfma_f32_32x32x16_bf16 v[88:103], v[164:167], a[172:175], v[88:103]
    ds_read_b64_tr_b16 v[160:161], v54 offset:20480
    ds_read_b64_tr_b16 v[162:163], v54 offset:21504
    buffer_load_dwordx4 a[208:211], v6, s[60:63], s14 offen offset:0 sc1
    s_waitcnt vmcnt(8) lgkmcnt(8)
    v_mfma_f32_32x32x16_bf16 v[88:103], v[152:155], a[176:179], v[88:103]
    ds_read_b64_tr_b16 v[164:165], v54 offset:22528
    ds_read_b64_tr_b16 v[166:167], v54 offset:23552
    buffer_load_dwordx4 a[212:215], v6, s[60:63], s14 offen offset:1024 sc1
    v_mfma_f32_32x32x16_bf16 v[104:119], v[172:175], a[164:167], v[104:119]
    ds_read_b64_tr_b16 v[168:169], v55 offset:16384
    ds_read_b64_tr_b16 v[170:171], v55 offset:17408
    v_mul_f32 v184, 0xbb124925, v184
    v_cvt_pk_bf16_f32 v68, v184, v184
    v_and_b32 v2, 0xffff0000, v68
    v_sub_f32 v2, v184, v2
    s_waitcnt vmcnt(8) lgkmcnt(8)
    v_mfma_f32_32x32x16_bf16 v[88:103], v[156:159], a[180:183], v[88:103]
    ds_read_b64_tr_b16 v[152:153], v54 offset:24576
    ds_read_b64_tr_b16 v[154:155], v54 offset:25600
    buffer_load_dwordx4 a[216:219], v6, s[60:63], s14 offen offset:2048 sc1
    v_mfma_f32_32x32x16_bf16 v[104:119], v[176:179], a[168:171], v[104:119]
    ds_read_b64_tr_b16 v[172:173], v55 offset:18432
    ds_read_b64_tr_b16 v[174:175], v55 offset:19456
    v_cvt_pk_bf16_f32 v69, v2, v2
    v_mul_f32 v4, 0x3b124925, v185
    v_fma_f32 v4, -v184, v184, v4
    v_max_f32_e64 v4, 0, v4
    s_waitcnt vmcnt(8) lgkmcnt(8)
    v_mfma_f32_32x32x16_bf16 v[88:103], v[160:163], a[184:187], v[88:103]
    ds_read_b64_tr_b16 v[156:157], v54 offset:26624
    ds_read_b64_tr_b16 v[158:159], v54 offset:27648
    buffer_load_dwordx4 a[220:223], v6, s[60:63], s14 offen offset:3072 sc1
    s_add_u32 s14, s14, 4096
    s_waitcnt vmcnt(8) lgkmcnt(8)
    v_mfma_f32_32x32x16_bf16 v[88:103], v[164:167], a[188:191], v[88:103]
    ds_read_b64_tr_b16 v[160:161], v54 offset:28672
    ds_read_b64_tr_b16 v[162:163], v54 offset:29696
    buffer_load_dwordx4 a[224:227], v6, s[60:63], s14 offen offset:0 sc1
    v_mfma_f32_32x32x16_bf16 v[104:119], v[180:183], a[172:175], v[104:119]
    ds_read_b64_tr_b16 v[176:177], v55 offset:20480
    ds_read_b64_tr_b16 v[178:179], v55 offset:21504
    v_add_f32 v5, 0x3727c5ac, v4
    v_fmac_f32 v4, 0x3727c5ac, v5
    v_rsq_f32 v5, v4
    s_waitcnt vmcnt(8) lgkmcnt(8)
    v_mfma_f32_32x32x16_bf16 v[88:103], v[152:155], a[192:195], v[88:103]
    ds_read_b64_tr_b16 v[164:165], v54 offset:30720
    ds_read_b64_tr_b16 v[166:167], v54 offset:31744
    buffer_load_dwordx4 a[228:231], v6, s[60:63], s14 offen offset:1024 sc1
    v_mfma_f32_32x32x16_bf16 v[104:119], v[168:171], a[176:179], v[104:119]
    ds_read_b64_tr_b16 v[180:181], v55 offset:22528
    ds_read_b64_tr_b16 v[182:183], v55 offset:23552
    v_cvt_f32_u32_e64 v2, v13
    v_mul_f32 v64, v4, v5
    v_fma_f32 v2, -v2, v64, v64
    v_cvt_pk_bf16_f32 v3, v2, v2
    s_waitcnt vmcnt(8) lgkmcnt(8)
    v_mfma_f32_32x32x16_bf16 v[88:103], v[156:159], a[196:199], v[88:103]
    ds_read_b64_tr_b16 v[152:153], v54 offset:32768
    ds_read_b64_tr_b16 v[154:155], v54 offset:33792
    buffer_load_dwordx4 a[232:235], v6, s[60:63], s14 offen offset:2048 sc1
    v_mfma_f32_32x32x16_bf16 v[104:119], v[172:175], a[180:183], v[104:119]
    ds_read_b64_tr_b16 v[168:169], v55 offset:24576
    ds_read_b64_tr_b16 v[170:171], v55 offset:25600
    v_and_b32 v3, 0xffff0000, v3
    v_sub_f32_e64 v3, v2, v3
    v_cvt_pk_bf16_f32 v70, v2, v3
    v_and_b32 v4, 0xffff0000, v70
    v_sub_f32_e64 v3, v3, v4
    v_cvt_pk_bf16_f32 v71, v3, v3
    v_mul_f32 v60, 0xc0135761, v5
    v_mul_f32 v4, v5, v5
    v_mul_f32 v4, v4, v5
    v_mul_f32 v62, 0xbdd2d3e8, v4
    s_mul_i32 s12, s19, 28672
    s_add_u32 s12, s12, 6291456
    s_xor_b32 s32, s19, 1
    s_mul_i32 s32, s32, 28672
    s_add_u32 s32, s32, 6291456
    v_add_u32 v19, s12, v6
    v_add_u32 v20, s32, v6
    v_add_u32 v19, s16, v19
    v_add_u32 v20, s16, v20
    v_mfma_f32_32x32x16_bf16 v[88:103], v[72:75], v[68:71], v[88:103]
    s_waitcnt vmcnt(8) lgkmcnt(10)
    v_mfma_f32_32x32x16_bf16 v[88:103], v[160:163], a[200:203], v[88:103]
    ds_read_b64_tr_b16 v[156:157], v54 offset:34816
    ds_read_b64_tr_b16 v[158:159], v54 offset:35840
    buffer_load_dwordx4 a[236:239], v6, s[60:63], s14 offen offset:3072 sc1
    s_add_u32 s14, s14, 4096
    s_waitcnt vmcnt(8) lgkmcnt(8)
    v_mfma_f32_32x32x16_bf16 v[88:103], v[164:167], a[204:207], v[88:103]
    ds_read_b64_tr_b16 v[160:161], v54 offset:36864
    ds_read_b64_tr_b16 v[162:163], v54 offset:37888
    buffer_load_dwordx4 a[240:243], v6, s[60:63], s14 offen offset:0 sc1
    v_mfma_f32_32x32x16_bf16 v[104:119], v[176:179], a[184:187], v[104:119]
    ds_read_b64_tr_b16 v[172:173], v55 offset:26624
    ds_read_b64_tr_b16 v[174:175], v55 offset:27648
    s_waitcnt vmcnt(8) lgkmcnt(8)
    v_mfma_f32_32x32x16_bf16 v[88:103], v[152:155], a[208:211], v[88:103]
    ds_read_b64_tr_b16 v[164:165], v54 offset:38912
    ds_read_b64_tr_b16 v[166:167], v54 offset:39936
    buffer_load_dwordx4 a[244:247], v6, s[60:63], s14 offen offset:1024 sc1
    v_mfma_f32_32x32x16_bf16 v[104:119], v[180:183], a[188:191], v[104:119]
    ds_read_b64_tr_b16 v[176:177], v55 offset:28672
    ds_read_b64_tr_b16 v[178:179], v55 offset:29696
    s_waitcnt vmcnt(8) lgkmcnt(8)
    v_mfma_f32_32x32x16_bf16 v[88:103], v[156:159], a[212:215], v[88:103]
    ds_read_b64_tr_b16 v[152:153], v54 offset:40960
    ds_read_b64_tr_b16 v[154:155], v54 offset:41984
    buffer_load_dwordx4 a[248:251], v6, s[60:63], s14 offen offset:2048 sc1
    s_waitcnt vmcnt(8) lgkmcnt(8)
    v_mfma_f32_32x32x16_bf16 v[88:103], v[160:163], a[216:219], v[88:103]
    ds_read_b64_tr_b16 v[156:157], v54 offset:43008
    ds_read_b64_tr_b16 v[158:159], v54 offset:44032
    buffer_load_dwordx4 a[252:255], v6, s[60:63], s14 offen offset:3072 sc1
    v_mfma_f32_32x32x16_bf16 v[104:119], v[168:171], a[192:195], v[104:119]
    ds_read_b64_tr_b16 v[180:181], v55 offset:30720
    ds_read_b64_tr_b16 v[182:183], v55 offset:31744
    s_waitcnt vmcnt(8) lgkmcnt(8)
    v_mfma_f32_32x32x16_bf16 v[88:103], v[164:167], a[220:223], v[88:103]
    ds_read_b64_tr_b16 v[160:161], v54 offset:45056
    ds_read_b64_tr_b16 v[162:163], v54 offset:46080
    v_mfma_f32_32x32x16_bf16 v[104:119], v[172:175], a[196:199], v[104:119]
    ds_read_b64_tr_b16 v[168:169], v55 offset:32768
    ds_read_b64_tr_b16 v[170:171], v55 offset:33792
    s_waitcnt vmcnt(7) lgkmcnt(8)
    v_mfma_f32_32x32x16_bf16 v[88:103], v[152:155], a[224:227], v[88:103]
    ds_read_b64_tr_b16 v[164:165], v54 offset:47104
    ds_read_b64_tr_b16 v[166:167], v54 offset:48128
    v_mfma_f32_32x32x16_bf16 v[104:119], v[176:179], a[200:203], v[104:119]
    ds_read_b64_tr_b16 v[172:173], v55 offset:34816
    ds_read_b64_tr_b16 v[174:175], v55 offset:35840
    s_waitcnt vmcnt(6) lgkmcnt(10)
    v_mfma_f32_32x32x16_bf16 v[88:103], v[156:159], a[228:231], v[88:103]
    ds_read_b64_tr_b16 v[152:153], v54 offset:49152
    ds_read_b64_tr_b16 v[154:155], v54 offset:50176
    s_waitcnt vmcnt(5) lgkmcnt(8)
    v_mfma_f32_32x32x16_bf16 v[88:103], v[160:163], a[232:235], v[88:103]
    ds_read_b64_tr_b16 v[156:157], v54 offset:51200
    ds_read_b64_tr_b16 v[158:159], v54 offset:52224
    v_mfma_f32_32x32x16_bf16 v[104:119], v[180:183], a[204:207], v[104:119]
    ds_read_b64_tr_b16 v[176:177], v55 offset:36864
    ds_read_b64_tr_b16 v[178:179], v55 offset:37888
    s_waitcnt vmcnt(4) lgkmcnt(8)
    v_mfma_f32_32x32x16_bf16 v[88:103], v[164:167], a[236:239], v[88:103]
    ds_read_b64_tr_b16 v[160:161], v54 offset:53248
    ds_read_b64_tr_b16 v[162:163], v54 offset:54272
    v_mfma_f32_32x32x16_bf16 v[104:119], v[168:171], a[208:211], v[104:119]
    ds_read_b64_tr_b16 v[180:181], v55 offset:38912
    ds_read_b64_tr_b16 v[182:183], v55 offset:39936
    s_waitcnt vmcnt(3) lgkmcnt(8)
    v_mfma_f32_32x32x16_bf16 v[88:103], v[152:155], a[240:243], v[88:103]
    ds_read_b64_tr_b16 v[164:165], v54 offset:55296
    ds_read_b64_tr_b16 v[166:167], v54 offset:56320
    s_waitcnt vmcnt(2) lgkmcnt(8)
    v_mfma_f32_32x32x16_bf16 v[88:103], v[156:159], a[244:247], v[88:103]
    v_mfma_f32_32x32x16_bf16 v[104:119], v[172:175], a[212:215], v[104:119]
    ds_read_b64_tr_b16 v[168:169], v55 offset:40960
    ds_read_b64_tr_b16 v[170:171], v55 offset:41984
    s_waitcnt vmcnt(1) lgkmcnt(6)
    v_mfma_f32_32x32x16_bf16 v[88:103], v[160:163], a[248:251], v[88:103]
    v_mfma_f32_32x32x16_bf16 v[104:119], v[176:179], a[216:219], v[104:119]
    ds_read_b64_tr_b16 v[172:173], v55 offset:43008
    ds_read_b64_tr_b16 v[174:175], v55 offset:44032
    s_waitcnt vmcnt(0) lgkmcnt(4)
    v_mfma_f32_32x32x16_bf16 v[88:103], v[164:167], a[252:255], v[88:103]
    v_mfma_f32_32x32x16_bf16 v[104:119], v[180:183], a[220:223], v[104:119]
    ds_read_b64_tr_b16 v[176:177], v55 offset:45056
    ds_read_b64_tr_b16 v[178:179], v55 offset:46080
    v_mfma_f32_32x32x16_bf16 v[104:119], v[76:79], v[68:71], v[104:119]
    v_mfma_f32_32x32x16_bf16 v[120:135], v[80:83], v[68:71], 0
    s_nop 6
    v_pk_mul_f32 v[184:185], v[88:89], v[88:89]
    v_pk_mul_f32 v[186:187], v[90:91], v[90:91]
    v_pk_mul_f32 v[188:189], v[92:93], v[92:93]
    v_pk_mul_f32 v[190:191], v[94:95], v[94:95]
    v_pk_fma_f32 v[184:185], v[184:185], v[62:63], v[60:61] op_sel_hi:[1,0,0]
    v_pk_fma_f32 v[186:187], v[186:187], v[62:63], v[60:61] op_sel_hi:[1,0,0]
    v_pk_fma_f32 v[188:189], v[188:189], v[62:63], v[60:61] op_sel_hi:[1,0,0]
    v_pk_fma_f32 v[190:191], v[190:191], v[62:63], v[60:61] op_sel_hi:[1,0,0]
    v_pk_mul_f32 v[184:185], v[184:185], v[88:89]
    v_pk_mul_f32 v[186:187], v[186:187], v[90:91]
    v_pk_mul_f32 v[188:189], v[188:189], v[92:93]
    v_pk_mul_f32 v[190:191], v[190:191], v[94:95]
    v_exp_f32 v184, v184
    v_exp_f32 v185, v185
    v_exp_f32 v186, v186
    v_exp_f32 v187, v187
    v_exp_f32 v188, v188
    v_exp_f32 v189, v189
    v_exp_f32 v190, v190
    v_exp_f32 v191, v191
    v_pk_fma_f32 v[184:185], v[184:185], v[64:65], v[64:65] op_sel_hi:[1,0,0]
    v_pk_fma_f32 v[186:187], v[186:187], v[64:65], v[64:65] op_sel_hi:[1,0,0]
    v_pk_fma_f32 v[188:189], v[188:189], v[64:65], v[64:65] op_sel_hi:[1,0,0]
    v_pk_fma_f32 v[190:191], v[190:191], v[64:65], v[64:65] op_sel_hi:[1,0,0]
    v_rcp_f32 v184, v184
    v_rcp_f32 v185, v185
    v_rcp_f32 v186, v186
    v_rcp_f32 v187, v187
    v_rcp_f32 v188, v188
    v_rcp_f32 v189, v189
    v_rcp_f32 v190, v190
    v_rcp_f32 v191, v191
    v_pk_mul_f32 v[184:185], v[184:185], v[88:89]
    v_pk_mul_f32 v[186:187], v[186:187], v[90:91]
    v_pk_mul_f32 v[188:189], v[188:189], v[92:93]
    v_pk_mul_f32 v[190:191], v[190:191], v[94:95]
    v_cvt_pk_bf16_f32 v200, v184, v185
    v_cvt_pk_bf16_f32 v201, v186, v187
    v_cvt_pk_bf16_f32 v202, v188, v189
    v_cvt_pk_bf16_f32 v203, v190, v191
    buffer_store_dwordx4 v[200:203], v6, s[60:63], s33 offen offset:0 sc1
    v_pk_mul_f32 v[192:193], v[96:97], v[96:97]
    v_pk_mul_f32 v[194:195], v[98:99], v[98:99]
    v_pk_mul_f32 v[196:197], v[100:101], v[100:101]
    v_pk_mul_f32 v[198:199], v[102:103], v[102:103]
    v_pk_fma_f32 v[192:193], v[192:193], v[62:63], v[60:61] op_sel_hi:[1,0,0]
    v_pk_fma_f32 v[194:195], v[194:195], v[62:63], v[60:61] op_sel_hi:[1,0,0]
    v_pk_fma_f32 v[196:197], v[196:197], v[62:63], v[60:61] op_sel_hi:[1,0,0]
    v_pk_fma_f32 v[198:199], v[198:199], v[62:63], v[60:61] op_sel_hi:[1,0,0]
    v_pk_mul_f32 v[192:193], v[192:193], v[96:97]
    v_pk_mul_f32 v[194:195], v[194:195], v[98:99]
    v_pk_mul_f32 v[196:197], v[196:197], v[100:101]
    v_pk_mul_f32 v[198:199], v[198:199], v[102:103]
    v_exp_f32 v192, v192
    v_exp_f32 v193, v193
    v_exp_f32 v194, v194
    v_exp_f32 v195, v195
    v_exp_f32 v196, v196
    v_exp_f32 v197, v197
    v_exp_f32 v198, v198
    v_exp_f32 v199, v199
    v_pk_fma_f32 v[192:193], v[192:193], v[64:65], v[64:65] op_sel_hi:[1,0,0]
    v_pk_fma_f32 v[194:195], v[194:195], v[64:65], v[64:65] op_sel_hi:[1,0,0]
    v_pk_fma_f32 v[196:197], v[196:197], v[64:65], v[64:65] op_sel_hi:[1,0,0]
    v_pk_fma_f32 v[198:199], v[198:199], v[64:65], v[64:65] op_sel_hi:[1,0,0]
    v_rcp_f32 v192, v192
    v_rcp_f32 v193, v193
    v_rcp_f32 v194, v194
    v_rcp_f32 v195, v195
    v_rcp_f32 v196, v196
    v_rcp_f32 v197, v197
    v_rcp_f32 v198, v198
    v_rcp_f32 v199, v199
    v_pk_mul_f32 v[192:193], v[192:193], v[96:97]
    v_pk_mul_f32 v[194:195], v[194:195], v[98:99]
    v_pk_mul_f32 v[196:197], v[196:197], v[100:101]
    v_pk_mul_f32 v[198:199], v[198:199], v[102:103]
    v_cvt_pk_bf16_f32 v204, v192, v193
    v_cvt_pk_bf16_f32 v205, v194, v195
    v_cvt_pk_bf16_f32 v206, v196, v197
    v_cvt_pk_bf16_f32 v207, v198, v199
    buffer_store_dwordx4 v[204:207], v6, s[60:63], s33 offen offset:1024 sc1
    s_add_u32 s33, s33, 1835008
    s_waitcnt lgkmcnt(4)
    v_mfma_f32_32x32x16_bf16 v[104:119], v[168:171], a[224:227], v[104:119]
    ds_read_b64_tr_b16 v[180:181], v55 offset:47104
    ds_read_b64_tr_b16 v[182:183], v55 offset:48128
    s_add_u32 m0, s17, 114688
    s_mov_b32 s92, 917504
    buffer_load_dwordx4 v15, s[68:71], s92 offen lds
    s_waitcnt lgkmcnt(4)
    v_mfma_f32_32x32x16_bf16 v[104:119], v[172:175], a[228:231], v[104:119]
    ds_read_b64_tr_b16 v[168:169], v55 offset:49152
    ds_read_b64_tr_b16 v[170:171], v55 offset:50176
    buffer_load_dwordx4 v16, s[68:71], s92 offen offset:1024 lds
    s_waitcnt lgkmcnt(4)
    v_mfma_f32_32x32x16_bf16 v[104:119], v[176:179], a[232:235], v[104:119]
    ds_read_b64_tr_b16 v[172:173], v55 offset:51200
    ds_read_b64_tr_b16 v[174:175], v55 offset:52224
    s_add_u32 m0, s17, 122880
    s_mov_b32 s92, 1146880
    buffer_load_dwordx4 v15, s[68:71], s92 offen lds
    s_waitcnt lgkmcnt(4)
    v_mfma_f32_32x32x16_bf16 v[104:119], v[180:183], a[236:239], v[104:119]
    ds_read_b64_tr_b16 v[176:177], v55 offset:53248
    ds_read_b64_tr_b16 v[178:179], v55 offset:54272
    buffer_load_dwordx4 v16, s[68:71], s92 offen offset:1024 lds
    s_waitcnt lgkmcnt(4)
    v_mfma_f32_32x32x16_bf16 v[104:119], v[168:171], a[240:243], v[104:119]
    ds_read_b64_tr_b16 v[180:181], v55 offset:55296
    ds_read_b64_tr_b16 v[182:183], v55 offset:56320
    s_add_u32 m0, s17, 131072
    s_mov_b32 s92, 1376256
    buffer_load_dwordx4 v15, s[68:71], s92 offen lds
    s_waitcnt lgkmcnt(4)
    v_mfma_f32_32x32x16_bf16 v[104:119], v[172:175], a[244:247], v[104:119]
    buffer_load_dwordx4 v16, s[68:71], s92 offen offset:1024 lds
    s_waitcnt lgkmcnt(2)
    v_mfma_f32_32x32x16_bf16 v[104:119], v[176:179], a[248:251], v[104:119]
    s_add_u32 m0, s17, 139264
    s_mov_b32 s92, 28672
    buffer_load_dwordx4 v15, s[68:71], s92 offen lds
    s_waitcnt lgkmcnt(0)
    v_mfma_f32_32x32x16_bf16 v[104:119], v[180:183], a[252:255], v[104:119]
    buffer_load_dwordx4 v16, s[68:71], s92 offen offset:1024 lds
    v_mfma_f32_32x32x16_bf16 v[136:151], v[84:87], v[68:71], 0
    ds_read_b64_tr_b16 v[152:153], v56 offset:0
    ds_read_b64_tr_b16 v[154:155], v56 offset:1024
    ds_read_b64_tr_b16 v[156:157], v56 offset:2048
    ds_read_b64_tr_b16 v[158:159], v56 offset:3072
    ds_read_b64_tr_b16 v[160:161], v56 offset:4096
    ds_read_b64_tr_b16 v[162:163], v56 offset:5120
    ds_read_b64_tr_b16 v[164:165], v56 offset:6144
    ds_read_b64_tr_b16 v[166:167], v56 offset:7168
    ds_read_b64_tr_b16 v[168:169], v56 offset:8192
    ds_read_b64_tr_b16 v[170:171], v56 offset:9216
    s_barrier
    v_pk_mul_f32 v[184:185], v[104:105], v[104:105]
    v_pk_mul_f32 v[186:187], v[106:107], v[106:107]
    v_pk_mul_f32 v[188:189], v[108:109], v[108:109]
    v_pk_mul_f32 v[190:191], v[110:111], v[110:111]
    v_pk_fma_f32 v[184:185], v[184:185], v[62:63], v[60:61] op_sel_hi:[1,0,0]
    s_add_u32 m0, s17, 0
    s_mov_b32 s92, 1175552
    buffer_load_dwordx4 v15, s[68:71], s92 offen lds
    v_pk_fma_f32 v[186:187], v[186:187], v[62:63], v[60:61] op_sel_hi:[1,0,0]
    v_pk_fma_f32 v[188:189], v[188:189], v[62:63], v[60:61] op_sel_hi:[1,0,0]
    v_pk_fma_f32 v[190:191], v[190:191], v[62:63], v[60:61] op_sel_hi:[1,0,0]
    v_pk_mul_f32 v[184:185], v[184:185], v[104:105]
    v_pk_mul_f32 v[186:187], v[186:187], v[106:107]
    v_pk_mul_f32 v[188:189], v[188:189], v[108:109]
    v_pk_mul_f32 v[190:191], v[190:191], v[110:111]
    v_exp_f32 v184, v184
    v_exp_f32 v185, v185
    v_exp_f32 v186, v186
    buffer_load_dwordx4 v16, s[68:71], s92 offen offset:1024 lds
    v_exp_f32 v187, v187
    v_exp_f32 v188, v188
    v_exp_f32 v189, v189
    v_exp_f32 v190, v190
    v_exp_f32 v191, v191
    v_pk_fma_f32 v[184:185], v[184:185], v[64:65], v[64:65] op_sel_hi:[1,0,0]
    v_pk_fma_f32 v[186:187], v[186:187], v[64:65], v[64:65] op_sel_hi:[1,0,0]
    v_pk_fma_f32 v[188:189], v[188:189], v[64:65], v[64:65] op_sel_hi:[1,0,0]
    v_pk_fma_f32 v[190:191], v[190:191], v[64:65], v[64:65] op_sel_hi:[1,0,0]
    v_rcp_f32_e64 v184, v184
    s_add_u32 m0, s17, 8192
    s_mov_b32 s92, 1404928
    buffer_load_dwordx4 v15, s[68:71], s92 offen lds
    v_rcp_f32_e64 v185, v185
    v_rcp_f32 v186, v186
    v_rcp_f32 v187, v187
    v_rcp_f32 v188, v188
    v_rcp_f32 v189, v189
    v_rcp_f32 v190, v190
    buffer_load_dwordx4 v16, s[68:71], s92 offen offset:1024 lds
    v_rcp_f32 v191, v191
    v_pk_mul_f32 v[184:185], v[184:185], v[104:105]
    v_pk_mul_f32 v[186:187], v[186:187], v[106:107]
    v_pk_mul_f32 v[188:189], v[188:189], v[108:109]
    v_pk_mul_f32 v[190:191], v[190:191], v[110:111]
    v_cvt_pk_bf16_f32 v208, v184, v185
    v_cvt_pk_bf16_f32 v209, v186, v187
    v_cvt_pk_bf16_f32 v210, v188, v189
    v_cvt_pk_bf16_f32 v211, v190, v191
    buffer_store_dwordx4 v[208:211], v6, s[60:63], s33 offen offset:0 sc1
    s_add_u32 m0, s17, 16384
    s_mov_b32 s92, 57344
    buffer_load_dwordx4 v15, s[68:71], s92 offen lds
    v_pk_mul_f32 v[192:193], v[112:113], v[112:113]
    v_pk_mul_f32 v[194:195], v[114:115], v[114:115]
    v_pk_mul_f32 v[196:197], v[116:117], v[116:117]
    v_pk_mul_f32 v[198:199], v[118:119], v[118:119]
    v_pk_fma_f32 v[192:193], v[192:193], v[62:63], v[60:61] op_sel_hi:[1,0,0]
    v_pk_fma_f32 v[194:195], v[194:195], v[62:63], v[60:61] op_sel_hi:[1,0,0]
    v_pk_fma_f32 v[196:197], v[196:197], v[62:63], v[60:61] op_sel_hi:[1,0,0]
    v_pk_fma_f32 v[198:199], v[198:199], v[62:63], v[60:61] op_sel_hi:[1,0,0]
    v_pk_mul_f32 v[192:193], v[192:193], v[112:113]
    v_pk_mul_f32 v[194:195], v[194:195], v[114:115]
    v_pk_mul_f32 v[196:197], v[196:197], v[116:117]
    v_pk_mul_f32 v[198:199], v[198:199], v[118:119]
    v_exp_f32 v192, v192
    buffer_load_dwordx4 v16, s[68:71], s92 offen offset:1024 lds
    v_exp_f32 v193, v193
    v_exp_f32 v194, v194
    v_exp_f32 v195, v195
    v_exp_f32 v196, v196
    v_exp_f32 v197, v197
    v_exp_f32 v198, v198
    v_exp_f32 v199, v199
    v_pk_fma_f32 v[192:193], v[192:193], v[64:65], v[64:65] op_sel_hi:[1,0,0]
    v_pk_fma_f32 v[194:195], v[194:195], v[64:65], v[64:65] op_sel_hi:[1,0,0]
    v_pk_fma_f32 v[196:197], v[196:197], v[64:65], v[64:65] op_sel_hi:[1,0,0]
    v_pk_fma_f32 v[198:199], v[198:199], v[64:65], v[64:65] op_sel_hi:[1,0,0]
    v_rcp_f32 v192, v192
    v_rcp_f32 v193, v193
    v_rcp_f32 v194, v194
    v_rcp_f32 v195, v195
    v_rcp_f32 v196, v196
    v_rcp_f32 v197, v197
    v_rcp_f32 v198, v198
    v_rcp_f32 v199, v199
    v_pk_mul_f32 v[192:193], v[192:193], v[112:113]
    v_pk_mul_f32 v[194:195], v[194:195], v[114:115]
    v_pk_mul_f32 v[196:197], v[196:197], v[116:117]
    v_pk_mul_f32 v[198:199], v[198:199], v[118:119]
    v_cvt_pk_bf16_f32 v212, v192, v193
    v_cvt_pk_bf16_f32 v213, v194, v195
    v_cvt_pk_bf16_f32 v214, v196, v197
    v_cvt_pk_bf16_f32 v215, v198, v199
    buffer_store_dwordx4 v[212:215], v6, s[60:63], s33 offen offset:1024 sc1
    s_add_u32 s33, s33, 1835008
    s_waitcnt vmcnt(14)
    ds_read_b64_tr_b16 a[32:33], v50 offset:49152
    ds_read_b64_tr_b16 a[34:35], v50 offset:50176
    ds_read_b64_tr_b16 a[36:37], v51 offset:49152
    ds_read_b64_tr_b16 a[38:39], v51 offset:50176
    s_waitcnt vmcnt(12)
    ds_read_b64_tr_b16 a[40:41], v50 offset:57344
    ds_read_b64_tr_b16 a[42:43], v50 offset:58368
    ds_read_b64_tr_b16 a[44:45], v51 offset:57344
    ds_read_b64_tr_b16 a[46:47], v51 offset:58368
    s_waitcnt vmcnt(10)
    ds_read_b64_tr_b16 a[48:49], v52 offset:0
    ds_read_b64_tr_b16 a[50:51], v52 offset:1024
    ds_read_b64_tr_b16 a[52:53], v53 offset:0
    ds_read_b64_tr_b16 a[54:55], v53 offset:1024
    s_waitcnt vmcnt(8)
    ds_read_b64_tr_b16 a[56:57], v52 offset:8192
    ds_read_b64_tr_b16 a[58:59], v52 offset:9216
    ds_read_b64_tr_b16 a[60:61], v53 offset:8192
    ds_read_b64_tr_b16 a[62:63], v53 offset:9216
    s_barrier
    buffer_store_dword v7, v10, s[60:63], s24 offen sc1
    s_waitcnt lgkmcnt(15)
    v_mfma_f32_32x32x16_bf16 v[120:135], v[152:155], a[144:147], v[120:135]
    ds_read_b64_tr_b16 v[172:173], v56 offset:10240
    ds_read_b64_tr_b16 v[174:175], v56 offset:11264
    s_add_u32 m0, s17, 24576
    s_mov_b32 s92, 286720
    buffer_load_dwordx4 v15, s[68:71], s92 offen lds
    v_mfma_f32_32x32x16_bf16 v[120:135], v[156:159], a[148:151], v[120:135]
    ds_read_b64_tr_b16 v[176:177], v56 offset:12288
    ds_read_b64_tr_b16 v[178:179], v56 offset:13312
    v_mfma_f32_32x32x16_bf16 v[120:135], v[160:163], a[152:155], v[120:135]
    ds_read_b64_tr_b16 v[180:181], v56 offset:14336
    ds_read_b64_tr_b16 v[182:183], v56 offset:15360
    buffer_load_dwordx4 v16, s[68:71], s92 offen offset:1024 lds
    v_mfma_f32_32x32x16_bf16 v[120:135], v[164:167], a[156:159], v[120:135]
    ds_read_b64_tr_b16 v[152:153], v56 offset:16384
    ds_read_b64_tr_b16 v[154:155], v56 offset:17408
    v_mfma_f32_32x32x16_bf16 v[120:135], v[168:171], a[160:163], v[120:135]
    ds_read_b64_tr_b16 v[156:157], v56 offset:18432
    ds_read_b64_tr_b16 v[158:159], v56 offset:19456
    s_add_u32 m0, s17, 32768
    s_mov_b32 s92, 516096
    buffer_load_dwordx4 v15, s[68:71], s92 offen lds
    s_waitcnt lgkmcnt(8)
    v_mfma_f32_32x32x16_bf16 v[120:135], v[172:175], a[164:167], v[120:135]
    ds_read_b64_tr_b16 v[160:161], v56 offset:20480
    ds_read_b64_tr_b16 v[162:163], v56 offset:21504
    s_waitcnt lgkmcnt(8)
    v_mfma_f32_32x32x16_bf16 v[120:135], v[176:179], a[168:171], v[120:135]
    ds_read_b64_tr_b16 v[164:165], v56 offset:22528
    ds_read_b64_tr_b16 v[166:167], v56 offset:23552
    buffer_load_dwordx4 v16, s[68:71], s92 offen offset:1024 lds
    s_waitcnt lgkmcnt(8)
    v_mfma_f32_32x32x16_bf16 v[120:135], v[180:183], a[172:175], v[120:135]
    ds_read_b64_tr_b16 v[168:169], v56 offset:24576
    ds_read_b64_tr_b16 v[170:171], v56 offset:25600
    s_waitcnt lgkmcnt(8)
    v_mfma_f32_32x32x16_bf16 v[120:135], v[152:155], a[176:179], v[120:135]
    ds_read_b64_tr_b16 v[172:173], v56 offset:26624
    ds_read_b64_tr_b16 v[174:175], v56 offset:27648
    s_add_u32 m0, s17, 40960
    s_mov_b32 s92, 745472
    buffer_load_dwordx4 v15, s[68:71], s92 offen lds
    s_waitcnt lgkmcnt(8)
    v_mfma_f32_32x32x16_bf16 v[120:135], v[156:159], a[180:183], v[120:135]
    ds_read_b64_tr_b16 v[176:177], v56 offset:28672
    ds_read_b64_tr_b16 v[178:179], v56 offset:29696
    s_waitcnt lgkmcnt(8)
    v_mfma_f32_32x32x16_bf16 v[120:135], v[160:163], a[184:187], v[120:135]
    ds_read_b64_tr_b16 v[180:181], v56 offset:30720
    ds_read_b64_tr_b16 v[182:183], v56 offset:31744
    buffer_load_dwordx4 v16, s[68:71], s92 offen offset:1024 lds
    s_waitcnt lgkmcnt(8)
    v_mfma_f32_32x32x16_bf16 v[120:135], v[164:167], a[188:191], v[120:135]
    ds_read_b64_tr_b16 v[152:153], v56 offset:32768
    ds_read_b64_tr_b16 v[154:155], v56 offset:33792
    s_waitcnt lgkmcnt(8)
    v_mfma_f32_32x32x16_bf16 v[120:135], v[168:171], a[192:195], v[120:135]
    ds_read_b64_tr_b16 v[156:157], v56 offset:34816
    ds_read_b64_tr_b16 v[158:159], v56 offset:35840
    s_add_u32 m0, s17, 49152
    s_mov_b32 s92, 974848
    buffer_load_dwordx4 v15, s[68:71], s92 offen lds
    s_waitcnt lgkmcnt(8)
    v_mfma_f32_32x32x16_bf16 v[120:135], v[172:175], a[196:199], v[120:135]
    ds_read_b64_tr_b16 v[160:161], v56 offset:36864
    ds_read_b64_tr_b16 v[162:163], v56 offset:37888
    s_waitcnt lgkmcnt(8)
    v_mfma_f32_32x32x16_bf16 v[120:135], v[176:179], a[200:203], v[120:135]
    ds_read_b64_tr_b16 v[164:165], v56 offset:38912
    ds_read_b64_tr_b16 v[166:167], v56 offset:39936
    buffer_load_dwordx4 v16, s[68:71], s92 offen offset:1024 lds
    s_waitcnt lgkmcnt(8)
    v_mfma_f32_32x32x16_bf16 v[120:135], v[180:183], a[204:207], v[120:135]
    ds_read_b64_tr_b16 v[168:169], v56 offset:40960
    ds_read_b64_tr_b16 v[170:171], v56 offset:41984
    s_waitcnt lgkmcnt(8)
    v_mfma_f32_32x32x16_bf16 v[120:135], v[152:155], a[208:211], v[120:135]
    ds_read_b64_tr_b16 v[172:173], v56 offset:43008
    ds_read_b64_tr_b16 v[174:175], v56 offset:44032
    s_add_u32 m0, s17, 147456
    s_mov_b32 s92, 1204224
    buffer_load_dwordx4 v15, s[68:71], s92 offen lds
    s_waitcnt lgkmcnt(8)
    v_mfma_f32_32x32x16_bf16 v[120:135], v[156:159], a[212:215], v[120:135]
    ds_read_b64_tr_b16 v[176:177], v56 offset:45056
    ds_read_b64_tr_b16 v[178:179], v56 offset:46080
    s_waitcnt lgkmcnt(8)
    v_mfma_f32_32x32x16_bf16 v[120:135], v[160:163], a[216:219], v[120:135]
    ds_read_b64_tr_b16 v[180:181], v56 offset:47104
    ds_read_b64_tr_b16 v[182:183], v56 offset:48128
    buffer_load_dwordx4 v16, s[68:71], s92 offen offset:1024 lds
    s_waitcnt lgkmcnt(8)
    v_mfma_f32_32x32x16_bf16 v[120:135], v[164:167], a[220:223], v[120:135]
    ds_read_b64_tr_b16 v[152:153], v56 offset:49152
    ds_read_b64_tr_b16 v[154:155], v56 offset:50176
    s_waitcnt lgkmcnt(8)
    v_mfma_f32_32x32x16_bf16 v[120:135], v[168:171], a[224:227], v[120:135]
    ds_read_b64_tr_b16 v[156:157], v56 offset:51200
    ds_read_b64_tr_b16 v[158:159], v56 offset:52224
    s_add_u32 m0, s17, 155648
    s_mov_b32 s92, 1433600
    buffer_load_dwordx4 v15, s[68:71], s92 offen lds
    s_waitcnt lgkmcnt(8)
    v_mfma_f32_32x32x16_bf16 v[120:135], v[172:175], a[228:231], v[120:135]
    ds_read_b64_tr_b16 v[160:161], v56 offset:53248
    ds_read_b64_tr_b16 v[162:163], v56 offset:54272
    s_add_u32 s28, s28, 65536
    buffer_load_dword v8, v9, s[60:63], s28 offen sc1
    s_waitcnt lgkmcnt(8)
    v_mfma_f32_32x32x16_bf16 v[120:135], v[176:179], a[232:235], v[120:135]
    ds_read_b64_tr_b16 v[164:165], v56 offset:55296
    ds_read_b64_tr_b16 v[166:167], v56 offset:56320
    buffer_load_dwordx4 v16, s[68:71], s92 offen offset:1024 lds
    s_waitcnt lgkmcnt(8)
    v_mfma_f32_32x32x16_bf16 v[120:135], v[180:183], a[236:239], v[120:135]
    s_waitcnt lgkmcnt(6)
    v_mfma_f32_32x32x16_bf16 v[120:135], v[152:155], a[240:243], v[120:135]
    s_add_u32 m0, s17, 114688
    s_mov_b32 s92, 258048
    buffer_load_dwordx4 v15, s[68:71], s92 offen lds
    s_waitcnt lgkmcnt(4)
    v_mfma_f32_32x32x16_bf16 v[120:135], v[156:159], a[244:247], v[120:135]
    s_waitcnt lgkmcnt(2)
    v_mfma_f32_32x32x16_bf16 v[120:135], v[160:163], a[248:251], v[120:135]
    buffer_load_dwordx4 v16, s[68:71], s92 offen offset:1024 lds
    s_waitcnt lgkmcnt(0)
    v_mfma_f32_32x32x16_bf16 v[120:135], v[164:167], a[252:255], v[120:135]
    ds_read_b64_tr_b16 v[152:153], v57 offset:0
    ds_read_b64_tr_b16 v[154:155], v57 offset:1024
    ds_read_b64_tr_b16 v[156:157], v57 offset:2048
    ds_read_b64_tr_b16 v[158:159], v57 offset:3072
    ds_read_b64_tr_b16 v[160:161], v57 offset:4096
    ds_read_b64_tr_b16 v[162:163], v57 offset:5120
    ds_read_b64_tr_b16 v[164:165], v57 offset:6144
    ds_read_b64_tr_b16 v[166:167], v57 offset:7168
    ds_read_b64_tr_b16 v[168:169], v57 offset:8192
    ds_read_b64_tr_b16 v[170:171], v57 offset:9216
    s_nop 1
    v_pk_mul_f32 v[184:185], v[120:121], v[120:121]
    s_add_u32 m0, s17, 122880
    s_mov_b32 s92, 487424
    buffer_load_dwordx4 v15, s[68:71], s92 offen lds
    v_pk_mul_f32 v[186:187], v[122:123], v[122:123]
    v_pk_mul_f32 v[188:189], v[124:125], v[124:125]
    v_pk_mul_f32 v[190:191], v[126:127], v[126:127]
    v_pk_fma_f32 v[184:185], v[184:185], v[62:63], v[60:61] op_sel_hi:[1,0,0]
    v_pk_fma_f32 v[186:187], v[186:187], v[62:63], v[60:61] op_sel_hi:[1,0,0]
    v_pk_fma_f32 v[188:189], v[188:189], v[62:63], v[60:61] op_sel_hi:[1,0,0]
    v_pk_fma_f32 v[190:191], v[190:191], v[62:63], v[60:61] op_sel_hi:[1,0,0]
    buffer_load_dwordx4 v16, s[68:71], s92 offen offset:1024 lds
    v_pk_mul_f32 v[184:185], v[184:185], v[120:121]
    v_pk_mul_f32 v[186:187], v[186:187], v[122:123]
    v_pk_mul_f32 v[188:189], v[188:189], v[124:125]
    v_pk_mul_f32 v[190:191], v[190:191], v[126:127]
    v_exp_f32 v184, v184
    v_exp_f32 v185, v185
    v_exp_f32_e64 v186, v186
    s_add_u32 m0, s17, 131072
    s_mov_b32 s92, 716800
    buffer_load_dwordx4 v15, s[68:71], s92 offen lds
    v_exp_f32_e64 v187, v187
    v_exp_f32 v188, v188
    v_exp_f32 v189, v189
    v_exp_f32 v190, v190
    buffer_load_dwordx4 v16, s[68:71], s92 offen offset:1024 lds
    v_exp_f32 v191, v191
    v_pk_fma_f32 v[184:185], v[184:185], v[64:65], v[64:65] op_sel_hi:[1,0,0]
    v_pk_fma_f32 v[186:187], v[186:187], v[64:65], v[64:65] op_sel_hi:[1,0,0]
    v_pk_fma_f32 v[188:189], v[188:189], v[64:65], v[64:65] op_sel_hi:[1,0,0]
    v_pk_fma_f32 v[190:191], v[190:191], v[64:65], v[64:65] op_sel_hi:[1,0,0]
    v_rcp_f32_e64 v184, v184
    s_add_u32 m0, s17, 139264
    s_mov_b32 s92, 946176
    buffer_load_dwordx4 v15, s[68:71], s92 offen lds
    v_rcp_f32_e64 v185, v185
    v_rcp_f32 v186, v186
    v_rcp_f32 v187, v187
    v_rcp_f32 v188, v188
    buffer_load_dwordx4 v16, s[68:71], s92 offen offset:1024 lds
    v_rcp_f32 v189, v189
    v_rcp_f32 v190, v190
    v_rcp_f32 v191, v191
    v_pk_mul_f32 v[184:185], v[184:185], v[120:121]
    v_pk_mul_f32 v[186:187], v[186:187], v[122:123]
    v_pk_mul_f32 v[188:189], v[188:189], v[124:125]
    v_pk_mul_f32 v[190:191], v[190:191], v[126:127]
    v_cvt_pk_bf16_f32 v200, v184, v185
    s_waitcnt vmcnt(22)
    s_barrier
    s_add_u32 s24, s24, 32768
    buffer_store_dword v7, v10, s[60:63], s24 offen sc1
    v_cvt_pk_bf16_f32 v201, v186, v187
    v_cvt_pk_bf16_f32 v202, v188, v189
    v_cvt_pk_bf16_f32 v203, v190, v191
    buffer_store_dwordx4 v[200:203], v6, s[60:63], s33 offen offset:0 sc1
    v_pk_mul_f32 v[192:193], v[128:129], v[128:129]
    v_pk_mul_f32 v[194:195], v[130:131], v[130:131]
    v_pk_mul_f32 v[196:197], v[132:133], v[132:133]
    v_pk_mul_f32 v[198:199], v[134:135], v[134:135]
    v_pk_fma_f32 v[192:193], v[192:193], v[62:63], v[60:61] op_sel_hi:[1,0,0]
    v_pk_fma_f32 v[194:195], v[194:195], v[62:63], v[60:61] op_sel_hi:[1,0,0]
    v_pk_fma_f32 v[196:197], v[196:197], v[62:63], v[60:61] op_sel_hi:[1,0,0]
    v_pk_fma_f32 v[198:199], v[198:199], v[62:63], v[60:61] op_sel_hi:[1,0,0]
    v_pk_mul_f32 v[192:193], v[192:193], v[128:129]
    v_pk_mul_f32 v[194:195], v[194:195], v[130:131]
    v_pk_mul_f32 v[196:197], v[196:197], v[132:133]
    v_pk_mul_f32 v[198:199], v[198:199], v[134:135]
    v_exp_f32 v192, v192
    v_exp_f32 v193, v193
    v_exp_f32 v194, v194
    v_exp_f32 v195, v195
    v_exp_f32 v196, v196
    v_exp_f32 v197, v197
    v_exp_f32 v198, v198
    v_exp_f32 v199, v199
    v_pk_fma_f32 v[192:193], v[192:193], v[64:65], v[64:65] op_sel_hi:[1,0,0]
    v_pk_fma_f32 v[194:195], v[194:195], v[64:65], v[64:65] op_sel_hi:[1,0,0]
    v_pk_fma_f32 v[196:197], v[196:197], v[64:65], v[64:65] op_sel_hi:[1,0,0]
    v_pk_fma_f32 v[198:199], v[198:199], v[64:65], v[64:65] op_sel_hi:[1,0,0]
    v_rcp_f32 v192, v192
    v_rcp_f32 v193, v193
    v_rcp_f32 v194, v194
    v_rcp_f32 v195, v195
    v_rcp_f32 v196, v196
    v_rcp_f32 v197, v197
    v_rcp_f32 v198, v198
    v_rcp_f32 v199, v199
    v_pk_mul_f32 v[192:193], v[192:193], v[128:129]
    v_pk_mul_f32 v[194:195], v[194:195], v[130:131]
    v_pk_mul_f32 v[196:197], v[196:197], v[132:133]
    v_pk_mul_f32 v[198:199], v[198:199], v[134:135]
    v_cvt_pk_bf16_f32 v204, v192, v193
    v_cvt_pk_bf16_f32 v205, v194, v195
    v_cvt_pk_bf16_f32 v206, v196, v197
    v_cvt_pk_bf16_f32 v207, v198, v199
    buffer_store_dwordx4 v[204:207], v6, s[60:63], s33 offen offset:1024 sc1
    s_add_u32 s33, s33, 1835008
    s_waitcnt vmcnt(12)
    v_cmp_ne_u32 vcc, v8, v7
    s_mov_b32 s13, 0
    s_cbranch_vccnz L_poll3
L_poll3_done:
    s_mov_b32 s34, 0
    buffer_load_dwordx4 a[64:67], v19, s[60:63], s34 offen sc1
    buffer_load_dwordx4 a[68:71], v20, s[60:63], s34 offen sc1
    s_mov_b32 s34, 4096
    buffer_load_dwordx4 a[72:75], v19, s[60:63], s34 offen sc1
    s_waitcnt lgkmcnt(8)
    v_mfma_f32_32x32x16_bf16 v[136:151], v[152:155], a[144:147], v[136:151]
    ds_read_b64_tr_b16 v[172:173], v57 offset:10240
    ds_read_b64_tr_b16 v[174:175], v57 offset:11264
    v_lshlrev_b32_e64 v2, 16, v36
    v_and_b32 v3, 0xffff0000, v36
    v_lshlrev_b32 v4, 16, v216
    v_and_b32 v89, 0xffff0000, v216
    s_waitcnt lgkmcnt(8)
    v_mfma_f32_32x32x16_bf16 v[136:151], v[156:159], a[148:151], v[136:151]
    ds_read_b64_tr_b16 v[176:177], v57 offset:12288
    ds_read_b64_tr_b16 v[178:179], v57 offset:13312
    buffer_load_dwordx4 a[76:79], v20, s[60:63], s34 offen sc1
    s_waitcnt lgkmcnt(8)
    v_mfma_f32_32x32x16_bf16 v[136:151], v[160:163], a[152:155], v[136:151]
    ds_read_b64_tr_b16 v[180:181], v57 offset:14336
    ds_read_b64_tr_b16 v[182:183], v57 offset:15360
    v_add_f32 v88, v2, v4
    v_add_f32_e64 v89, v3, v89
    v_lshlrev_b32 v2, 16, v37
    v_and_b32 v3, 0xffff0000, v37
    s_waitcnt lgkmcnt(8)
    v_mfma_f32_32x32x16_bf16 v[136:151], v[164:167], a[156:159], v[136:151]
    ds_read_b64_tr_b16 v[152:153], v57 offset:16384
    ds_read_b64_tr_b16 v[154:155], v57 offset:17408
    s_mov_b32 s34, 8192
    buffer_load_dwordx4 a[80:83], v19, s[60:63], s34 offen sc1
    s_waitcnt lgkmcnt(8)
    v_mfma_f32_32x32x16_bf16 v[136:151], v[168:171], a[160:163], v[136:151]
    ds_read_b64_tr_b16 v[156:157], v57 offset:18432
    ds_read_b64_tr_b16 v[158:159], v57 offset:19456
    v_lshlrev_b32 v4, 16, v217
    v_and_b32 v91, 0xffff0000, v217
    v_add_f32 v90, v2, v4
    v_add_f32_e64 v91, v3, v91
    s_waitcnt lgkmcnt(8)
    v_mfma_f32_32x32x16_bf16 v[136:151], v[172:175], a[164:167], v[136:151]
    ds_read_b64_tr_b16 v[160:161], v57 offset:20480
    ds_read_b64_tr_b16 v[162:163], v57 offset:21504
    buffer_load_dwordx4 a[84:87], v20, s[60:63], s34 offen sc1
    s_waitcnt lgkmcnt(8)
    v_mfma_f32_32x32x16_bf16 v[136:151], v[176:179], a[168:171], v[136:151]
    ds_read_b64_tr_b16 v[164:165], v57 offset:22528
    ds_read_b64_tr_b16 v[166:167], v57 offset:23552
    v_lshlrev_b32 v2, 16, v38
    v_and_b32 v3, 0xffff0000, v38
    v_lshlrev_b32 v4, 16, v218
    v_and_b32 v93, 0xffff0000, v218
    s_waitcnt lgkmcnt(8)
    v_mfma_f32_32x32x16_bf16 v[136:151], v[180:183], a[172:175], v[136:151]
    ds_read_b64_tr_b16 v[168:169], v57 offset:24576
    ds_read_b64_tr_b16 v[170:171], v57 offset:25600
    s_mov_b32 s34, 12288
    buffer_load_dwordx4 a[88:91], v19, s[60:63], s34 offen sc1
    s_waitcnt lgkmcnt(8)
    v_mfma_f32_32x32x16_bf16 v[136:151], v[152:155], a[176:179], v[136:151]
    ds_read_b64_tr_b16 v[172:173], v57 offset:26624
    ds_read_b64_tr_b16 v[174:175], v57 offset:27648
    v_add_f32 v92, v2, v4
    v_add_f32_e64 v93, v3, v93
    v_lshlrev_b32 v2, 16, v39
    v_and_b32 v3, 0xffff0000, v39
    s_waitcnt lgkmcnt(8)
    v_mfma_f32_32x32x16_bf16 v[136:151], v[156:159], a[180:183], v[136:151]
    ds_read_b64_tr_b16 v[176:177], v57 offset:28672
    ds_read_b64_tr_b16 v[178:179], v57 offset:29696
    buffer_load_dwordx4 a[92:95], v20, s[60:63], s34 offen sc1
    s_waitcnt lgkmcnt(8)
    v_mfma_f32_32x32x16_bf16 v[136:151], v[160:163], a[184:187], v[136:151]
    ds_read_b64_tr_b16 v[180:181], v57 offset:30720
    ds_read_b64_tr_b16 v[182:183], v57 offset:31744
    v_lshlrev_b32 v4, 16, v219
    v_and_b32 v95, 0xffff0000, v219
    v_add_f32 v94, v2, v4
    v_add_f32_e64 v95, v3, v95
    s_waitcnt lgkmcnt(8)
    v_mfma_f32_32x32x16_bf16 v[136:151], v[164:167], a[188:191], v[136:151]
    ds_read_b64_tr_b16 v[152:153], v57 offset:32768
    ds_read_b64_tr_b16 v[154:155], v57 offset:33792
    s_mov_b32 s34, 16384
    buffer_load_dwordx4 a[96:99], v19, s[60:63], s34 offen sc1
    s_waitcnt lgkmcnt(8)
    v_mfma_f32_32x32x16_bf16 v[136:151], v[168:171], a[192:195], v[136:151]
    ds_read_b64_tr_b16 v[156:157], v57 offset:34816
    ds_read_b64_tr_b16 v[158:159], v57 offset:35840
    v_lshlrev_b32 v2, 16, v40
    v_and_b32 v3, 0xffff0000, v40
    v_lshlrev_b32 v4, 16, v220
    v_and_b32 v97, 0xffff0000, v220
    s_waitcnt lgkmcnt(8)
    v_mfma_f32_32x32x16_bf16 v[136:151], v[172:175], a[196:199], v[136:151]
    ds_read_b64_tr_b16 v[160:161], v57 offset:36864
    ds_read_b64_tr_b16 v[162:163], v57 offset:37888
    buffer_load_dwordx4 a[100:103], v20, s[60:63], s34 offen sc1
    s_waitcnt lgkmcnt(8)
    v_mfma_f32_32x32x16_bf16 v[136:151], v[176:179], a[200:203], v[136:151]
    ds_read_b64_tr_b16 v[164:165], v57 offset:38912
    ds_read_b64_tr_b16 v[166:167], v57 offset:39936
    v_add_f32 v96, v2, v4
    v_add_f32_e64 v97, v3, v97
    v_lshlrev_b32 v2, 16, v41
    v_and_b32 v3, 0xffff0000, v41
    s_waitcnt lgkmcnt(8)
    v_mfma_f32_32x32x16_bf16 v[136:151], v[180:183], a[204:207], v[136:151]
    ds_read_b64_tr_b16 v[168:169], v57 offset:40960
    ds_read_b64_tr_b16 v[170:171], v57 offset:41984
    s_mov_b32 s34, 20480
    buffer_load_dwordx4 a[104:107], v19, s[60:63], s34 offen sc1
    s_waitcnt lgkmcnt(8)
    v_mfma_f32_32x32x16_bf16 v[136:151], v[152:155], a[208:211], v[136:151]
    ds_read_b64_tr_b16 v[172:173], v57 offset:43008
    ds_read_b64_tr_b16 v[174:175], v57 offset:44032
    v_lshlrev_b32 v4, 16, v221
    v_and_b32 v99, 0xffff0000, v221
    v_add_f32 v98, v2, v4
    v_add_f32_e64 v99, v3, v99
    s_waitcnt lgkmcnt(8)
    v_mfma_f32_32x32x16_bf16 v[136:151], v[156:159], a[212:215], v[136:151]
    ds_read_b64_tr_b16 v[176:177], v57 offset:45056
    ds_read_b64_tr_b16 v[178:179], v57 offset:46080
    buffer_load_dwordx4 a[108:111], v20, s[60:63], s34 offen sc1
    s_waitcnt lgkmcnt(8)
    v_mfma_f32_32x32x16_bf16 v[136:151], v[160:163], a[216:219], v[136:151]
    ds_read_b64_tr_b16 v[180:181], v57 offset:47104
    ds_read_b64_tr_b16 v[182:183], v57 offset:48128
    v_lshlrev_b32 v2, 16, v42
    v_and_b32 v3, 0xffff0000, v42
    v_lshlrev_b32 v4, 16, v222
    v_and_b32 v101, 0xffff0000, v222
    s_waitcnt lgkmcnt(8)
    v_mfma_f32_32x32x16_bf16 v[136:151], v[164:167], a[220:223], v[136:151]
    ds_read_b64_tr_b16 v[152:153], v57 offset:49152
    ds_read_b64_tr_b16 v[154:155], v57 offset:50176
    s_mov_b32 s34, 24576
    buffer_load_dwordx4 a[112:115], v19, s[60:63], s34 offen sc1
    s_waitcnt lgkmcnt(8)
    v_mfma_f32_32x32x16_bf16 v[136:151], v[168:171], a[224:227], v[136:151]
    ds_read_b64_tr_b16 v[156:157], v57 offset:51200
    ds_read_b64_tr_b16 v[158:159], v57 offset:52224
    v_add_f32 v100, v2, v4
    v_add_f32_e64 v101, v3, v101
    v_lshlrev_b32 v2, 16, v43
    v_and_b32 v3, 0xffff0000, v43
    s_waitcnt lgkmcnt(8)
    v_mfma_f32_32x32x16_bf16 v[136:151], v[172:175], a[228:231], v[136:151]
    ds_read_b64_tr_b16 v[160:161], v57 offset:53248
    ds_read_b64_tr_b16 v[162:163], v57 offset:54272
    s_add_u32 s28, s28, 32768
    buffer_load_dword v8, v9, s[60:63], s28 offen sc1
    s_waitcnt lgkmcnt(8)
    v_mfma_f32_32x32x16_bf16 v[136:151], v[176:179], a[232:235], v[136:151]
    ds_read_b64_tr_b16 v[164:165], v57 offset:55296
    ds_read_b64_tr_b16 v[166:167], v57 offset:56320
    v_lshlrev_b32 v4, 16, v223
    v_and_b32 v103, 0xffff0000, v223
    v_add_f32 v102, v2, v4
    v_add_f32_e64 v103, v3, v103
    s_waitcnt lgkmcnt(8)
    v_mfma_f32_32x32x16_bf16 v[136:151], v[180:183], a[236:239], v[136:151]
    buffer_load_dwordx4 a[116:119], v20, s[60:63], s34 offen sc1
    s_waitcnt lgkmcnt(6)
    v_mfma_f32_32x32x16_bf16 v[136:151], v[152:155], a[240:243], v[136:151]
    s_waitcnt lgkmcnt(4)
    v_mfma_f32_32x32x16_bf16 v[136:151], v[156:159], a[244:247], v[136:151]
    s_waitcnt lgkmcnt(2)
    v_mfma_f32_32x32x16_bf16 v[136:151], v[160:163], a[248:251], v[136:151]
    s_waitcnt lgkmcnt(0)
    v_mfma_f32_32x32x16_bf16 v[136:151], v[164:167], a[252:255], v[136:151]
    s_barrier
    s_nop 10
    v_pk_mul_f32 v[184:185], v[136:137], v[136:137]
    s_add_u32 m0, s17, 57344
    s_mov_b32 s92, 86016
    buffer_load_dwordx4 v15, s[68:71], s92 offen lds
    v_pk_mul_f32 v[186:187], v[138:139], v[138:139]
    v_pk_mul_f32 v[188:189], v[140:141], v[140:141]
    v_pk_mul_f32 v[190:191], v[142:143], v[142:143]
    v_pk_fma_f32 v[184:185], v[184:185], v[62:63], v[60:61] op_sel_hi:[1,0,0]
    v_pk_fma_f32 v[186:187], v[186:187], v[62:63], v[60:61] op_sel_hi:[1,0,0]
    v_pk_fma_f32 v[188:189], v[188:189], v[62:63], v[60:61] op_sel_hi:[1,0,0]
    v_pk_fma_f32 v[190:191], v[190:191], v[62:63], v[60:61] op_sel_hi:[1,0,0]
    v_pk_mul_f32 v[184:185], v[184:185], v[136:137]
    buffer_load_dwordx4 v16, s[68:71], s92 offen offset:1024 lds
    v_pk_mul_f32 v[186:187], v[186:187], v[138:139]
    v_pk_mul_f32 v[188:189], v[188:189], v[140:141]
    v_pk_mul_f32 v[190:191], v[190:191], v[142:143]
    v_exp_f32 v184, v184
    v_exp_f32 v185, v185
    v_exp_f32 v186, v186
    v_exp_f32 v187, v187
    s_add_u32 m0, s17, 65536
    s_mov_b32 s92, 315392
    buffer_load_dwordx4 v15, s[68:71], s92 offen lds
    v_exp_f32 v188, v188
    v_exp_f32 v189, v189
    v_exp_f32 v190, v190
    v_exp_f32 v191, v191
    v_pk_fma_f32 v[184:185], v[184:185], v[64:65], v[64:65] op_sel_hi:[1,0,0]
    buffer_load_dwordx4 v16, s[68:71], s92 offen offset:1024 lds
    v_pk_fma_f32 v[186:187], v[186:187], v[64:65], v[64:65] op_sel_hi:[1,0,0]
    v_pk_fma_f32 v[188:189], v[188:189], v[64:65], v[64:65] op_sel_hi:[1,0,0]
    v_pk_fma_f32 v[190:191], v[190:191], v[64:65], v[64:65] op_sel_hi:[1,0,0]
    v_rcp_f32 v184, v184
    v_rcp_f32 v185, v185
    v_rcp_f32 v186, v186
    v_rcp_f32 v187, v187
    s_add_u32 m0, s17, 73728
    s_mov_b32 s92, 544768
    buffer_load_dwordx4 v15, s[68:71], s92 offen lds
    v_rcp_f32 v188, v188
    v_rcp_f32 v189, v189
    v_rcp_f32 v190, v190
    v_rcp_f32 v191, v191
    v_pk_mul_f32 v[184:185], v[184:185], v[136:137]
    buffer_load_dwordx4 v16, s[68:71], s92 offen offset:1024 lds
    v_pk_mul_f32 v[186:187], v[186:187], v[138:139]
    v_pk_mul_f32 v[188:189], v[188:189], v[140:141]
    v_pk_mul_f32 v[190:191], v[190:191], v[142:143]
    v_cvt_pk_bf16_f32 v208, v184, v185
    s_waitcnt vmcnt(21)
    s_barrier
    s_add_u32 s24, s24, 32768
    buffer_store_dword v7, v10, s[60:63], s24 offen sc1
    s_waitcnt vmcnt(8)
    v_cmp_ne_u32 vcc, v8, v7
    s_mov_b32 s13, 0
    s_cbranch_vccnz L_poll4
L_poll4_done:
    s_mov_b32 s34, 1835008
    buffer_load_dwordx4 a[120:123], v19, s[60:63], s34 offen sc1
    v_cvt_pk_bf16_f32 v209, v186, v187
    v_cvt_pk_bf16_f32 v210, v188, v189
    v_cvt_pk_bf16_f32 v211, v190, v191
    buffer_store_dwordx4 v[208:211], v6, s[60:63], s33 offen offset:0 sc1
    v_pk_mul_f32 v[192:193], v[144:145], v[144:145]
    v_pk_mul_f32 v[194:195], v[146:147], v[146:147]
    buffer_load_dwordx4 a[124:127], v20, s[60:63], s34 offen sc1
    v_pk_mul_f32 v[196:197], v[148:149], v[148:149]
    v_pk_mul_f32 v[198:199], v[150:151], v[150:151]
    v_pk_fma_f32 v[192:193], v[192:193], v[62:63], v[60:61] op_sel_hi:[1,0,0]
    v_pk_fma_f32 v[194:195], v[194:195], v[62:63], v[60:61] op_sel_hi:[1,0,0]
    v_pk_fma_f32 v[196:197], v[196:197], v[62:63], v[60:61] op_sel_hi:[1,0,0]
    v_pk_fma_f32 v[198:199], v[198:199], v[62:63], v[60:61] op_sel_hi:[1,0,0]
    v_pk_mul_f32 v[192:193], v[192:193], v[144:145]
    v_pk_mul_f32 v[194:195], v[194:195], v[146:147]
    v_pk_mul_f32 v[196:197], v[196:197], v[148:149]
    v_pk_mul_f32 v[198:199], v[198:199], v[150:151]
    v_exp_f32 v192, v192
    v_exp_f32 v193, v193
    v_exp_f32 v194, v194
    v_exp_f32 v195, v195
    v_exp_f32 v196, v196
    v_exp_f32 v197, v197
    v_exp_f32 v198, v198
    v_exp_f32 v199, v199
    v_pk_fma_f32 v[192:193], v[192:193], v[64:65], v[64:65] op_sel_hi:[1,0,0]
    v_pk_fma_f32 v[194:195], v[194:195], v[64:65], v[64:65] op_sel_hi:[1,0,0]
    v_pk_fma_f32 v[196:197], v[196:197], v[64:65], v[64:65] op_sel_hi:[1,0,0]
    v_pk_fma_f32 v[198:199], v[198:199], v[64:65], v[64:65] op_sel_hi:[1,0,0]
    v_rcp_f32 v192, v192
    v_rcp_f32 v193, v193
    v_rcp_f32 v194, v194
    v_rcp_f32 v195, v195
    v_rcp_f32 v196, v196
    v_rcp_f32 v197, v197
    v_rcp_f32 v198, v198
    v_rcp_f32 v199, v199
    v_pk_mul_f32 v[192:193], v[192:193], v[144:145]
    v_pk_mul_f32 v[194:195], v[194:195], v[146:147]
    v_pk_mul_f32 v[196:197], v[196:197], v[148:149]
    v_pk_mul_f32 v[198:199], v[198:199], v[150:151]
    v_cvt_pk_bf16_f32 v212, v192, v193
    v_cvt_pk_bf16_f32 v213, v194, v195
    v_cvt_pk_bf16_f32 v214, v196, v197
    v_cvt_pk_bf16_f32 v215, v198, v199
    buffer_store_dwordx4 v[212:215], v6, s[60:63], s33 offen offset:1024 sc1
    s_add_u32 s33, s33, 1835008
    v_mfma_f32_32x32x16_bf16 v[88:103], a[0:3], a[64:67], v[88:103]
    s_mov_b32 s34, 1839104
    buffer_load_dwordx4 a[128:131], v19, s[60:63], s34 offen sc1
    v_mfma_f32_32x32x16_bf16 v[104:119], a[4:7], a[64:67], 0
    v_xor_b32 v21, 2048, v19
    v_xor_b32 v54, 4096, v48
    v_mfma_f32_32x32x16_bf16 v[120:135], a[0:3], a[68:71], 0
    buffer_load_dwordx4 a[132:135], v20, s[60:63], s34 offen sc1
    v_mfma_f32_32x32x16_bf16 v[136:151], a[4:7], a[68:71], 0
    v_xor_b32 v55, 4096, v49
    v_xor_b32 v56, 4096, v50
    v_mfma_f32_32x32x16_bf16 v[88:103], a[8:11], a[72:75], v[88:103]
    s_mov_b32 s34, 1843200
    buffer_load_dwordx4 a[136:139], v19, s[60:63], s34 offen sc1
    v_mfma_f32_32x32x16_bf16 v[104:119], a[12:15], a[72:75], v[104:119]
    v_xor_b32 v57, 4096, v51
    v_xor_b32 v72, 4096, v52
    v_mfma_f32_32x32x16_bf16 v[120:135], a[8:11], a[76:79], v[120:135]
    buffer_load_dwordx4 a[140:143], v20, s[60:63], s34 offen sc1
    v_mfma_f32_32x32x16_bf16 v[136:151], a[12:15], a[76:79], v[136:151]
    v_xor_b32 v73, 4096, v53
    v_add_u32_e64 v59, s17, v6
    v_mfma_f32_32x32x16_bf16 v[88:103], a[16:19], a[80:83], v[88:103]
    s_mov_b32 s34, 1847296
    buffer_load_dwordx4 a[144:147], v19, s[60:63], s34 offen sc1
    v_mfma_f32_32x32x16_bf16 v[104:119], a[20:23], a[80:83], v[104:119]
    v_add_u32 v74, 114688, v59
    v_xor_b32 v75, 4096, v74
    v_mfma_f32_32x32x16_bf16 v[120:135], a[16:19], a[84:87], v[120:135]
    buffer_load_dwordx4 a[148:151], v20, s[60:63], s34 offen sc1
    v_mfma_f32_32x32x16_bf16 v[136:151], a[20:23], a[84:87], v[136:151]
    v_xor_b32 v5, 2048, v59
    v_and_b32_e64 v2, 31, v1
    v_mfma_f32_32x32x16_bf16 v[88:103], a[24:27], a[88:91], v[88:103]
    s_mov_b32 s34, 1851392
    buffer_load_dwordx4 a[152:155], v19, s[60:63], s34 offen sc1
    v_mfma_f32_32x32x16_bf16 v[104:119], a[28:31], a[88:91], v[104:119]
    v_mul_u32_u24 v2, 896, v2
    v_lshl_add_u32 v58, v13, 4, v2
    v_mfma_f32_32x32x16_bf16 v[120:135], a[24:27], a[92:95], v[120:135]
    buffer_load_dwordx4 a[156:159], v20, s[60:63], s34 offen sc1
    v_mfma_f32_32x32x16_bf16 v[136:151], a[28:31], a[92:95], v[136:151]
    s_mul_i32 s12, s19, 28672
    s_lshl_b32 s14, s20, 6
    s_add_u32 s28, s28, 32768
    buffer_load_dword v8, v9, s[60:63], s28 offen sc1
    v_mfma_f32_32x32x16_bf16 v[88:103], a[32:35], a[96:99], v[88:103]
    s_mov_b32 s34, 1855488
    buffer_load_dwordx4 a[160:163], v19, s[60:63], s34 offen sc1
    v_mfma_f32_32x32x16_bf16 v[104:119], a[36:39], a[96:99], v[104:119]
    s_add_u32 s12, s12, s14
    v_mfma_f32_32x32x16_bf16 v[120:135], a[32:35], a[100:103], v[120:135]
    buffer_load_dwordx4 a[164:167], v20, s[60:63], s34 offen sc1
    v_mfma_f32_32x32x16_bf16 v[136:151], a[36:39], a[100:103], v[136:151]
    v_mfma_f32_32x32x16_bf16 v[88:103], a[40:43], a[104:107], v[88:103]
    s_mov_b32 s34, 1859584
    buffer_load_dwordx4 a[168:171], v19, s[60:63], s34 offen sc1
    v_mfma_f32_32x32x16_bf16 v[104:119], a[44:47], a[104:107], v[104:119]
    ds_read_b64_tr_b16 v[152:153], v50 offset:49152
    ds_read_b64_tr_b16 v[154:155], v50 offset:50176
    v_mfma_f32_32x32x16_bf16 v[120:135], a[40:43], a[108:111], v[120:135]
    buffer_load_dwordx4 a[172:175], v20, s[60:63], s34 offen sc1
    v_mfma_f32_32x32x16_bf16 v[136:151], a[44:47], a[108:111], v[136:151]
    ds_read_b64_tr_b16 v[156:157], v51 offset:49152
    ds_read_b64_tr_b16 v[158:159], v51 offset:50176
    v_mfma_f32_32x32x16_bf16 v[88:103], a[48:51], a[112:115], v[88:103]
    s_add_u32 m0, s17, 81920
    s_mov_b32 s92, 774144
    buffer_load_dwordx4 v15, s[68:71], s92 offen lds
    v_mfma_f32_32x32x16_bf16 v[104:119], a[52:55], a[112:115], v[104:119]
    ds_read_b64_tr_b16 v[160:161], v50 offset:57344
    ds_read_b64_tr_b16 v[162:163], v50 offset:58368
    s_waitcnt vmcnt(25)
    v_mfma_f32_32x32x16_bf16 v[120:135], a[48:51], a[116:119], v[120:135]
    buffer_load_dwordx4 v16, s[68:71], s92 offen offset:1024 lds
    v_mfma_f32_32x32x16_bf16 v[136:151], a[52:55], a[116:119], v[136:151]
    ds_read_b64_tr_b16 v[164:165], v51 offset:57344
    ds_read_b64_tr_b16 v[166:167], v51 offset:58368
    s_waitcnt vmcnt(18)
    v_mfma_f32_32x32x16_bf16 v[88:103], a[56:59], a[120:123], v[88:103]
    s_add_u32 m0, s17, 90112
    s_mov_b32 s92, 1003520
    buffer_load_dwordx4 v15, s[68:71], s92 offen lds
    v_mfma_f32_32x32x16_bf16 v[104:119], a[60:63], a[120:123], v[104:119]
    ds_read_b64_tr_b16 v[168:169], v52 offset:0
    ds_read_b64_tr_b16 v[170:171], v52 offset:1024
    s_waitcnt vmcnt(17)
    v_mfma_f32_32x32x16_bf16 v[120:135], a[56:59], a[124:127], v[120:135]
    buffer_load_dwordx4 v16, s[68:71], s92 offen offset:1024 lds
    v_mfma_f32_32x32x16_bf16 v[136:151], a[60:63], a[124:127], v[136:151]
    ds_read_b64_tr_b16 v[172:173], v53 offset:0
    ds_read_b64_tr_b16 v[174:175], v53 offset:1024
    s_waitcnt vmcnt(17)
    s_barrier
    s_add_u32 s24, s24, 32768
    buffer_store_dword v7, v10, s[60:63], s24 offen sc1
    s_waitcnt vmcnt(17) lgkmcnt(10)
    v_mfma_f32_32x32x16_bf16 v[88:103], v[152:155], a[128:131], v[88:103]
    s_add_u32 m0, s17, 98304
    s_mov_b32 s92, 1232896
    buffer_load_dwordx4 v15, s[68:71], s92 offen lds
    s_waitcnt lgkmcnt(8)
    v_mfma_f32_32x32x16_bf16 v[104:119], v[156:159], a[128:131], v[104:119]
    ds_read_b64_tr_b16 v[176:177], v52 offset:8192
    ds_read_b64_tr_b16 v[178:179], v52 offset:9216
    s_waitcnt vmcnt(17)
    v_mfma_f32_32x32x16_bf16 v[120:135], v[152:155], a[132:135], v[120:135]
    buffer_load_dwordx4 v16, s[68:71], s92 offen offset:1024 lds
    v_mfma_f32_32x32x16_bf16 v[136:151], v[156:159], a[132:135], v[136:151]
    ds_read_b64_tr_b16 v[180:181], v53 offset:8192
    ds_read_b64_tr_b16 v[182:183], v53 offset:9216
    s_waitcnt vmcnt(11)
    v_cmp_ne_u32 vcc, v8, v7
    s_mov_b32 s13, 0
    s_cbranch_vccnz L_poll5
L_poll5_done:
    s_waitcnt lgkmcnt(10)
    v_mfma_f32_32x32x16_bf16 v[88:103], v[160:163], a[136:139], v[88:103]
    s_mov_b32 s34, 3670016
    buffer_load_dwordx4 a[176:179], v19, s[60:63], s34 offen sc1
    s_waitcnt lgkmcnt(8)
    v_mfma_f32_32x32x16_bf16 v[104:119], v[164:167], a[136:139], v[104:119]
    buffer_load_dwordx4 a[180:183], v21, s[60:63], s34 offen sc1
    ds_read_b64_tr_b16 v[152:153], v48 offset:0
    ds_read_b64_tr_b16 v[154:155], v48 offset:1024
    v_mfma_f32_32x32x16_bf16 v[120:135], v[160:163], a[140:143], v[120:135]
    s_mov_b32 s34, 3674112
    buffer_load_dwordx4 a[184:187], v19, s[60:63], s34 offen sc1
    v_mfma_f32_32x32x16_bf16 v[136:151], v[164:167], a[140:143], v[136:151]
    ds_read_b64_tr_b16 v[156:157], v49 offset:0
    ds_read_b64_tr_b16 v[158:159], v49 offset:1024
    s_waitcnt lgkmcnt(10)
    v_mfma_f32_32x32x16_bf16 v[88:103], v[168:171], a[144:147], v[88:103]
    buffer_load_dwordx4 a[188:191], v21, s[60:63], s34 offen sc1
    s_waitcnt lgkmcnt(8)
    v_mfma_f32_32x32x16_bf16 v[104:119], v[172:175], a[144:147], v[104:119]
    s_mov_b32 s34, 3678208
    buffer_load_dwordx4 a[192:195], v19, s[60:63], s34 offen sc1
    ds_read_b64_tr_b16 v[160:161], v48 offset:8192
    ds_read_b64_tr_b16 v[162:163], v48 offset:9216
    v_mfma_f32_32x32x16_bf16 v[120:135], v[168:171], a[148:151], v[120:135]
    buffer_load_dwordx4 a[196:199], v21, s[60:63], s34 offen sc1
    v_mfma_f32_32x32x16_bf16 v[136:151], v[172:175], a[148:151], v[136:151]
    ds_read_b64_tr_b16 v[164:165], v49 offset:8192
    ds_read_b64_tr_b16 v[166:167], v49 offset:9216
    s_waitcnt lgkmcnt(10)
    v_mfma_f32_32x32x16_bf16 v[88:103], v[176:179], a[152:155], v[88:103]
    s_mov_b32 s34, 3682304
    buffer_load_dwordx4 a[200:203], v19, s[60:63], s34 offen sc1
    s_waitcnt lgkmcnt(8)
    v_mfma_f32_32x32x16_bf16 v[104:119], v[180:183], a[152:155], v[104:119]
    buffer_load_dwordx4 a[204:207], v21, s[60:63], s34 offen sc1
    v_mfma_f32_32x32x16_bf16 v[120:135], v[176:179], a[156:159], v[120:135]
    s_mov_b32 s34, 3686400
    buffer_load_dwordx4 a[208:211], v19, s[60:63], s34 offen sc1
    v_mfma_f32_32x32x16_bf16 v[136:151], v[180:183], a[156:159], v[136:151]
    s_waitcnt vmcnt(19) lgkmcnt(6)
    v_mfma_f32_32x32x16_bf16 v[88:103], v[152:155], a[160:163], v[88:103]
    buffer_load_dwordx4 a[212:215], v21, s[60:63], s34 offen sc1
    ds_read_b64_tr_b16 a[36:37], v49 offset:16384
    ds_read_b64_tr_b16 a[38:39], v49 offset:17408
    s_waitcnt lgkmcnt(6)
    v_mfma_f32_32x32x16_bf16 v[104:119], v[156:159], a[160:163], v[104:119]
    s_mov_b32 s34, 3690496
    buffer_load_dwordx4 a[216:219], v19, s[60:63], s34 offen sc1
    ds_read_b64_tr_b16 a[32:33], v48 offset:16384
    ds_read_b64_tr_b16 a[34:35], v48 offset:17408
    s_waitcnt vmcnt(20)
    v_mfma_f32_32x32x16_bf16 v[120:135], v[152:155], a[164:167], v[120:135]
    buffer_load_dwordx4 a[220:223], v21, s[60:63], s34 offen sc1
    ds_read_b64_tr_b16 a[44:45], v55 offset:16384
    ds_read_b64_tr_b16 a[46:47], v55 offset:17408
    v_mfma_f32_32x32x16_bf16 v[136:151], v[156:159], a[164:167], v[136:151]
    ds_read_b64_tr_b16 a[40:41], v54 offset:16384
    ds_read_b64_tr_b16 a[42:43], v54 offset:17408
    s_waitcnt vmcnt(20) lgkmcnt(10)
    v_mfma_f32_32x32x16_bf16 v[88:103], v[160:163], a[168:171], v[88:103]
    s_mov_b32 s34, 3694592
    buffer_load_dwordx4 a[224:227], v19, s[60:63], s34 offen sc1
    ds_read_b64_tr_b16 a[52:53], v49 offset:24576
    ds_read_b64_tr_b16 a[54:55], v49 offset:25600
    s_waitcnt lgkmcnt(10)
    v_mfma_f32_32x32x16_bf16 v[104:119], v[164:167], a[168:171], v[104:119]
    buffer_load_dwordx4 a[228:231], v21, s[60:63], s34 offen sc1
    ds_read_b64_tr_b16 a[48:49], v48 offset:24576
    ds_read_b64_tr_b16 a[50:51], v48 offset:25600
    s_waitcnt vmcnt(21)
    v_mfma_f32_32x32x16_bf16 v[120:135], v[160:163], a[172:175], v[120:135]
    s_add_u32 m0, s17, 106496
    s_mov_b32 s92, 1462272
    buffer_load_dwordx4 v15, s[68:71], s92 offen lds
    ds_read_b64_tr_b16 a[60:61], v55 offset:24576
    ds_read_b64_tr_b16 a[62:63], v55 offset:25600
    v_mfma_f32_32x32x16_bf16 v[136:151], v[164:167], a[172:175], v[136:151]
    ds_read_b64_tr_b16 a[56:57], v54 offset:24576
    ds_read_b64_tr_b16 a[58:59], v54 offset:25600
    s_add_u32 s28, s28, 32768
    buffer_load_dword v8, v9, s[60:63], s28 offen sc1
    s_waitcnt vmcnt(15) lgkmcnt(14)
    v_mfma_f32_32x32x16_bf16 v[104:119], a[36:39], a[176:179], v[104:119]
    buffer_load_dwordx4 v16, s[68:71], s92 offen offset:1024 lds
    ds_read_b64_tr_b16 a[4:5], v49 offset:32768
    ds_read_b64_tr_b16 a[6:7], v49 offset:33792
    s_waitcnt lgkmcnt(14)
    v_mfma_f32_32x32x16_bf16 v[88:103], a[32:35], a[176:179], v[88:103]
    ds_read_b64_tr_b16 a[0:1], v48 offset:32768
    ds_read_b64_tr_b16 a[2:3], v48 offset:33792
    s_waitcnt vmcnt(15) lgkmcnt(14)
    v_mfma_f32_32x32x16_bf16 v[104:119], a[44:47], a[180:183], v[104:119]
    ds_read_b64_tr_b16 a[12:13], v55 offset:32768
    ds_read_b64_tr_b16 a[14:15], v55 offset:33792
    s_waitcnt lgkmcnt(14)
    v_mfma_f32_32x32x16_bf16 v[88:103], a[40:43], a[180:183], v[88:103]
    ds_read_b64_tr_b16 a[8:9], v54 offset:32768
    ds_read_b64_tr_b16 a[10:11], v54 offset:33792
    ds_write_b128 v74, v[120:123] offset:0
    s_waitcnt vmcnt(14) lgkmcnt(15)
    v_mfma_f32_32x32x16_bf16 v[104:119], a[52:55], a[184:187], v[104:119]
    ds_read_b64_tr_b16 a[20:21], v49 offset:40960
    ds_read_b64_tr_b16 a[22:23], v49 offset:41984
    s_waitcnt lgkmcnt(15)
    v_mfma_f32_32x32x16_bf16 v[88:103], a[48:51], a[184:187], v[88:103]
    ds_read_b64_tr_b16 a[16:17], v48 offset:40960
    ds_read_b64_tr_b16 a[18:19], v48 offset:41984
    ds_write_b128 v74, v[128:131] offset:8192
    s_waitcnt vmcnt(13) lgkmcnt(15)
    v_mfma_f32_32x32x16_bf16 v[104:119], a[60:63], a[188:191], v[104:119]
    ds_read_b64_tr_b16 a[28:29], v55 offset:40960
    ds_read_b64_tr_b16 a[30:31], v55 offset:41984
    s_waitcnt lgkmcnt(15)
    v_mfma_f32_32x32x16_bf16 v[88:103], a[56:59], a[188:191], v[88:103]
    ds_read_b64_tr_b16 a[24:25], v54 offset:40960
    ds_read_b64_tr_b16 a[26:27], v54 offset:41984
    ds_write_b128 v74, v[124:127] offset:1024
    s_waitcnt vmcnt(12) lgkmcnt(15)
    v_mfma_f32_32x32x16_bf16 v[104:119], a[4:7], a[192:195], v[104:119]
    ds_read_b64_tr_b16 a[36:37], v49 offset:49152
    ds_read_b64_tr_b16 a[38:39], v49 offset:50176
    v_mfma_f32_32x32x16_bf16 v[88:103], a[0:3], a[192:195], v[88:103]
    ds_read_b64_tr_b16 a[32:33], v48 offset:49152
    ds_read_b64_tr_b16 a[34:35], v48 offset:50176
    ds_write_b128 v74, v[136:139] offset:16384
    s_waitcnt vmcnt(11) lgkmcnt(15)
    v_mfma_f32_32x32x16_bf16 v[104:119], a[12:15], a[196:199], v[104:119]
    ds_read_b64_tr_b16 a[44:45], v55 offset:49152
    ds_read_b64_tr_b16 a[46:47], v55 offset:50176
    v_mfma_f32_32x32x16_bf16 v[88:103], a[8:11], a[196:199], v[88:103]
    ds_read_b64_tr_b16 a[40:41], v54 offset:49152
    ds_read_b64_tr_b16 a[42:43], v54 offset:50176
    ds_write_b128 v74, v[132:135] offset:9216
    s_waitcnt vmcnt(10) lgkmcnt(15)
    v_mfma_f32_32x32x16_bf16 v[104:119], a[20:23], a[200:203], v[104:119]
    ds_read_b64_tr_b16 a[52:53], v53 offset:16384
    ds_read_b64_tr_b16 a[54:55], v53 offset:17408
    v_mfma_f32_32x32x16_bf16 v[88:103], a[16:19], a[200:203], v[88:103]
    ds_read_b64_tr_b16 a[48:49], v52 offset:16384
    ds_read_b64_tr_b16 a[50:51], v52 offset:17408
    ds_write_b128 v74, v[144:147] offset:24576
    s_waitcnt vmcnt(9) lgkmcnt(15)
    v_mfma_f32_32x32x16_bf16 v[104:119], a[28:31], a[204:207], v[104:119]
    ds_read_b64_tr_b16 a[60:61], v73 offset:16384
    ds_read_b64_tr_b16 a[62:63], v73 offset:17408
    v_mfma_f32_32x32x16_bf16 v[88:103], a[24:27], a[204:207], v[88:103]
    ds_read_b64_tr_b16 a[56:57], v72 offset:16384
    ds_read_b64_tr_b16 a[58:59], v72 offset:17408
    ds_write_b128 v74, v[140:143] offset:17408
    s_waitcnt vmcnt(1)
    v_cmp_ne_u32 vcc, v8, v7
    s_mov_b32 s13, 0
    s_cbranch_vccnz L_poll6
L_poll6_done:
    s_mov_b32 s34, 5505024
    buffer_load_dwordx4 a[232:235], v19, s[60:63], s34 offen sc1
    buffer_load_dwordx4 a[236:239], v21, s[60:63], s34 offen sc1
    s_mov_b32 s34, 5509120
    buffer_load_dwordx4 a[240:243], v19, s[60:63], s34 offen sc1
    buffer_load_dwordx4 a[244:247], v21, s[60:63], s34 offen sc1
    s_waitcnt lgkmcnt(15)
    v_mfma_f32_32x32x16_bf16 v[104:119], a[36:39], a[208:211], v[104:119]
    s_mov_b32 s34, 5513216
    buffer_load_dwordx4 a[248:251], v19, s[60:63], s34 offen sc1
    ds_read_b64_tr_b16 a[4:5], v53 offset:24576
    ds_read_b64_tr_b16 a[6:7], v53 offset:25600
    v_mfma_f32_32x32x16_bf16 v[88:103], a[32:35], a[208:211], v[88:103]
    buffer_load_dwordx4 a[252:255], v21, s[60:63], s34 offen sc1
    ds_read_b64_tr_b16 a[0:1], v52 offset:24576
    ds_read_b64_tr_b16 a[2:3], v52 offset:25600
    s_waitcnt lgkmcnt(15)
    v_mfma_f32_32x32x16_bf16 v[104:119], a[44:47], a[212:215], v[104:119]
    s_mov_b32 s34, 5517312
    buffer_load_dwordx4 a[64:67], v19, s[60:63], s34 offen sc1
    ds_read_b64_tr_b16 a[12:13], v73 offset:24576
    ds_read_b64_tr_b16 a[14:15], v73 offset:25600
    v_mfma_f32_32x32x16_bf16 v[88:103], a[40:43], a[212:215], v[88:103]
    ds_read_b64_tr_b16 a[8:9], v72 offset:24576
    ds_read_b64_tr_b16 a[10:11], v72 offset:25600
    ds_write_b128 v74, v[148:151] offset:25600
    s_waitcnt vmcnt(7) lgkmcnt(0)
    s_barrier
    v_mfma_f32_32x32x16_bf16 v[104:119], a[52:55], a[216:219], v[104:119]
    buffer_load_dwordx4 a[68:71], v21, s[60:63], s34 offen sc1
    ds_read_b64_tr_b16 a[20:21], v49 offset:57344
    ds_read_b64_tr_b16 a[22:23], v49 offset:58368
    v_mfma_f32_32x32x16_bf16 v[88:103], a[48:51], a[216:219], v[88:103]
    s_mov_b32 s34, 5521408
    buffer_load_dwordx4 a[72:75], v19, s[60:63], s34 offen sc1
    ds_read_b64_tr_b16 a[16:17], v48 offset:57344
    ds_read_b64_tr_b16 a[18:19], v48 offset:58368
    v_mfma_f32_32x32x16_bf16 v[104:119], a[60:63], a[220:223], v[104:119]
    buffer_load_dwordx4 a[76:79], v21, s[60:63], s34 offen sc1
    ds_read_b64_tr_b16 a[28:29], v55 offset:57344
    ds_read_b64_tr_b16 a[30:31], v55 offset:58368
    v_mfma_f32_32x32x16_bf16 v[88:103], a[56:59], a[220:223], v[88:103]
    ds_read_b64_tr_b16 a[24:25], v54 offset:57344
    ds_read_b64_tr_b16 a[26:27], v54 offset:58368
    ds_read_b128 v[120:123], v75 offset:0
    ds_read_b128 v[124:127], v75 offset:1024
    v_mfma_f32_32x32x16_bf16 v[104:119], a[4:7], a[224:227], v[104:119]
    s_mov_b32 s34, 5525504
    buffer_load_dwordx4 a[80:83], v19, s[60:63], s34 offen sc1
    ds_read_b64_tr_b16 a[36:37], v51 offset:0
    ds_read_b64_tr_b16 a[38:39], v51 offset:1024
    v_mfma_f32_32x32x16_bf16 v[88:103], a[0:3], a[224:227], v[88:103]
    buffer_load_dwordx4 a[84:87], v21, s[60:63], s34 offen sc1
    ds_read_b64_tr_b16 a[32:33], v50 offset:0
    ds_read_b64_tr_b16 a[34:35], v50 offset:1024
    v_mfma_f32_32x32x16_bf16 v[104:119], a[12:15], a[228:231], v[104:119]
    s_mov_b32 s34, 5529600
    buffer_load_dwordx4 a[88:91], v19, s[60:63], s34 offen sc1
    ds_read_b64_tr_b16 a[44:45], v57 offset:0
    ds_read_b64_tr_b16 a[46:47], v57 offset:1024
    v_mfma_f32_32x32x16_bf16 v[88:103], a[8:11], a[228:231], v[88:103]
    ds_read_b64_tr_b16 a[40:41], v56 offset:0
    ds_read_b64_tr_b16 a[42:43], v56 offset:1024
    ds_read_b128 v[128:131], v75 offset:8192
    ds_read_b128 v[132:135], v75 offset:9216
    s_waitcnt vmcnt(12) lgkmcnt(15)
    v_mfma_f32_32x32x16_bf16 v[104:119], a[20:23], a[232:235], v[104:119]
    buffer_load_dwordx4 a[92:95], v21, s[60:63], s34 offen sc1
    ds_read_b64_tr_b16 a[52:53], v51 offset:8192
    ds_read_b64_tr_b16 a[54:55], v51 offset:9216
    v_mfma_f32_32x32x16_bf16 v[88:103], a[16:19], a[232:235], v[88:103]
    ds_read_b64_tr_b16 a[48:49], v50 offset:8192
    ds_read_b64_tr_b16 a[50:51], v50 offset:9216
    s_waitcnt vmcnt(12) lgkmcnt(15)
    v_mfma_f32_32x32x16_bf16 v[104:119], a[28:31], a[236:239], v[104:119]
    ds_read_b64_tr_b16 a[60:61], v57 offset:8192
    ds_read_b64_tr_b16 a[62:63], v57 offset:9216
    v_mfma_f32_32x32x16_bf16 v[88:103], a[24:27], a[236:239], v[88:103]
    ds_read_b64_tr_b16 a[56:57], v56 offset:8192
    ds_read_b64_tr_b16 a[58:59], v56 offset:9216
    ds_read_b128 v[136:139], v75 offset:16384
    ds_read_b128 v[140:143], v75 offset:17408
    s_waitcnt vmcnt(11) lgkmcnt(15)
    v_mfma_f32_32x32x16_bf16 v[104:119], a[36:39], a[240:243], v[104:119]
    ds_read_b64_tr_b16 a[4:5], v51 offset:16384
    ds_read_b64_tr_b16 a[6:7], v51 offset:17408
    v_mfma_f32_32x32x16_bf16 v[88:103], a[32:35], a[240:243], v[88:103]
    ds_read_b64_tr_b16 a[0:1], v50 offset:16384
    ds_read_b64_tr_b16 a[2:3], v50 offset:17408
    s_waitcnt vmcnt(10) lgkmcnt(15)
    v_mfma_f32_32x32x16_bf16 v[104:119], a[44:47], a[244:247], v[104:119]
    ds_read_b64_tr_b16 a[12:13], v57 offset:16384
    ds_read_b64_tr_b16 a[14:15], v57 offset:17408
    v_mfma_f32_32x32x16_bf16 v[88:103], a[40:43], a[244:247], v[88:103]
    ds_read_b64_tr_b16 a[8:9], v56 offset:16384
    ds_read_b64_tr_b16 a[10:11], v56 offset:17408
    ds_read_b128 v[144:147], v75 offset:24576
    ds_read_b128 v[148:151], v75 offset:25600
    s_waitcnt vmcnt(9) lgkmcnt(15)
    v_mfma_f32_32x32x16_bf16 v[104:119], a[52:55], a[248:251], v[104:119]
    ds_read_b64_tr_b16 a[20:21], v51 offset:24576
    ds_read_b64_tr_b16 a[22:23], v51 offset:25600
    v_mfma_f32_32x32x16_bf16 v[88:103], a[48:51], a[248:251], v[88:103]
    ds_read_b64_tr_b16 a[16:17], v50 offset:24576
    ds_read_b64_tr_b16 a[18:19], v50 offset:25600
    s_waitcnt vmcnt(8) lgkmcnt(15)
    v_mfma_f32_32x32x16_bf16 v[104:119], a[60:63], a[252:255], v[104:119]
    ds_read_b64_tr_b16 a[28:29], v57 offset:24576
    ds_read_b64_tr_b16 a[30:31], v57 offset:25600
    v_mfma_f32_32x32x16_bf16 v[88:103], a[56:59], a[252:255], v[88:103]
    ds_read_b64_tr_b16 a[24:25], v56 offset:24576
    ds_read_b64_tr_b16 a[26:27], v56 offset:25600
    s_waitcnt vmcnt(7) lgkmcnt(15)
    v_mfma_f32_32x32x16_bf16 v[104:119], a[4:7], a[64:67], v[104:119]
    ds_read_b64_tr_b16 a[36:37], v51 offset:32768
    ds_read_b64_tr_b16 a[38:39], v51 offset:33792
    s_waitcnt lgkmcnt(15)
    v_mfma_f32_32x32x16_bf16 v[88:103], a[0:3], a[64:67], v[88:103]
    ds_read_b64_tr_b16 a[32:33], v50 offset:32768
    ds_read_b64_tr_b16 a[34:35], v50 offset:33792
    s_waitcnt vmcnt(6) lgkmcnt(15)
    v_mfma_f32_32x32x16_bf16 v[104:119], a[12:15], a[68:71], v[104:119]
    ds_read_b64_tr_b16 a[44:45], v57 offset:32768
    ds_read_b64_tr_b16 a[46:47], v57 offset:33792
    s_waitcnt lgkmcnt(15)
    v_mfma_f32_32x32x16_bf16 v[88:103], a[8:11], a[68:71], v[88:103]
    ds_read_b64_tr_b16 a[40:41], v56 offset:32768
    ds_read_b64_tr_b16 a[42:43], v56 offset:33792
    s_waitcnt vmcnt(5) lgkmcnt(14)
    v_mfma_f32_32x32x16_bf16 v[104:119], a[20:23], a[72:75], v[104:119]
    ds_read_b64_tr_b16 a[52:53], v51 offset:40960
    ds_read_b64_tr_b16 a[54:55], v51 offset:41984
    ds_read_b64_tr_b16 a[48:49], v50 offset:40960
    ds_read_b64_tr_b16 a[50:51], v50 offset:41984
    s_waitcnt vmcnt(4) lgkmcnt(14)
    v_mfma_f32_32x32x16_bf16 v[104:119], a[28:31], a[76:79], v[104:119]
    ds_read_b64_tr_b16 a[60:61], v57 offset:40960
    ds_read_b64_tr_b16 a[62:63], v57 offset:41984
    ds_read_b64_tr_b16 a[56:57], v56 offset:40960
    ds_read_b64_tr_b16 a[58:59], v56 offset:41984
    s_waitcnt vmcnt(3) lgkmcnt(14)
    v_mfma_f32_32x32x16_bf16 v[104:119], a[36:39], a[80:83], v[104:119]
    s_waitcnt vmcnt(2) lgkmcnt(10)
    v_mfma_f32_32x32x16_bf16 v[104:119], a[44:47], a[84:87], v[104:119]
    s_waitcnt vmcnt(1) lgkmcnt(6)
    v_mfma_f32_32x32x16_bf16 v[104:119], a[52:55], a[88:91], v[104:119]
    s_waitcnt vmcnt(0) lgkmcnt(2)
    v_mfma_f32_32x32x16_bf16 v[104:119], a[60:63], a[92:95], v[104:119]
    v_mfma_f32_32x32x16_bf16 v[88:103], a[16:19], a[72:75], v[88:103]
    v_mfma_f32_32x32x16_bf16 v[88:103], a[24:27], a[76:79], v[88:103]
    s_nop 9
    v_add_f32_e64 v104, v104, v136
    v_add_f32 v105, v105, v137
    v_add_f32 v106, v106, v138
    v_add_f32 v107, v107, v139
    ds_write_b128 v59, v[104:107] offset:0
    v_mfma_f32_32x32x16_bf16 v[88:103], a[32:35], a[80:83], v[88:103]
    v_add_f32 v108, v108, v140
    v_add_f32 v109, v109, v141
    v_add_f32 v110, v110, v142
    v_add_f32 v111, v111, v143
    ds_write_b128 v59, v[108:111] offset:1024
    v_mfma_f32_32x32x16_bf16 v[88:103], a[40:43], a[84:87], v[88:103]
    v_add_f32 v112, v112, v144
    v_add_f32 v113, v113, v145
    v_add_f32 v114, v114, v146
    v_add_f32 v115, v115, v147
    ds_write_b128 v59, v[112:115] offset:8192
    v_mfma_f32_32x32x16_bf16 v[88:103], a[48:51], a[88:91], v[88:103]
    v_add_f32 v116, v116, v148
    v_add_f32 v117, v117, v149
    v_add_f32 v118, v118, v150
    v_add_f32 v119, v119, v151
    ds_write_b128 v59, v[116:119] offset:9216
    s_waitcnt lgkmcnt(4)
    v_mfma_f32_32x32x16_bf16 v[88:103], a[56:59], a[92:95], v[88:103]
    s_waitcnt lgkmcnt(0)
    s_barrier
    ds_read_b128 v[136:139], v5 offset:0
    ds_read_b128 v[140:143], v5 offset:1024
    ds_read_b128 v[144:147], v5 offset:8192
    ds_read_b128 v[148:151], v5 offset:9216
    s_nop 5
    v_pk_add_f32 v[88:89], v[88:89], v[120:121]
    v_pk_add_f32 v[90:91], v[90:91], v[122:123]
    v_pk_add_f32 v[92:93], v[92:93], v[124:125]
    v_pk_add_f32 v[94:95], v[94:95], v[126:127]
    v_pk_add_f32 v[96:97], v[96:97], v[128:129]
    v_pk_add_f32 v[98:99], v[98:99], v[130:131]
    v_pk_add_f32 v[100:101], v[100:101], v[132:133]
    v_pk_add_f32 v[102:103], v[102:103], v[134:135]
    s_waitcnt lgkmcnt(3)
    v_pk_add_f32 v[88:89], v[88:89], v[136:137]
    v_pk_add_f32 v[90:91], v[90:91], v[138:139]
    s_waitcnt lgkmcnt(2)
    v_pk_add_f32 v[92:93], v[92:93], v[140:141]
    v_pk_add_f32 v[94:95], v[94:95], v[142:143]
    v_cvt_pk_bf16_f32 v200, v88, v89
    v_cvt_pk_bf16_f32 v201, v90, v91
    v_cvt_pk_bf16_f32 v202, v92, v93
    v_cvt_pk_bf16_f32 v203, v94, v95
    s_nop 0
    v_permlane32_swap_b32 v200, v202
    v_permlane32_swap_b32_e64 v201, v203
    buffer_store_dwordx4 v[200:203], v58, s[76:79], s12 offen offset:0
    s_waitcnt lgkmcnt(1)
    v_pk_add_f32 v[96:97], v[96:97], v[144:145]
    v_pk_add_f32 v[98:99], v[98:99], v[146:147]
    s_waitcnt lgkmcnt(0)
    v_pk_add_f32 v[100:101], v[100:101], v[148:149]
    v_pk_add_f32 v[102:103], v[102:103], v[150:151]
    v_cvt_pk_bf16_f32 v204, v96, v97
    v_cvt_pk_bf16_f32 v205, v98, v99
    v_cvt_pk_bf16_f32 v206, v100, v101
    v_cvt_pk_bf16_f32 v207, v102, v103
    s_nop 0
    v_permlane32_swap_b32 v204, v206
    v_permlane32_swap_b32 v205, v207
    buffer_store_dwordx4 v[204:207], v58, s[76:79], s12 offen offset:32
    s_branch L_fin
L_idle:
    s_sub_u32 s12, s3, 28
    s_lshl_b32 s12, s12, 2
    s_add_u32 s12, s12, s4
    s_mul_i32 s12, s12, 114688
    v_lshl_add_u32 v24, v1, 7, s12
    s_mov_b32 s12, 0
    buffer_load_dword a116, v24, s[68:71], s12 offen
    s_mov_b32 s12, 8192
    buffer_load_dword a116, v24, s[68:71], s12 offen
    s_mov_b32 s12, 16384
    buffer_load_dword a116, v24, s[68:71], s12 offen
    s_mov_b32 s12, 24576
    buffer_load_dword a116, v24, s[68:71], s12 offen
    s_mov_b32 s12, 32768
    buffer_load_dword a116, v24, s[68:71], s12 offen
    s_mov_b32 s12, 40960
    buffer_load_dword a116, v24, s[68:71], s12 offen
    s_mov_b32 s12, 49152
    buffer_load_dword a116, v24, s[68:71], s12 offen
    s_mov_b32 s12, 57344
    buffer_load_dword a116, v24, s[68:71], s12 offen
    s_mov_b32 s12, 65536
    buffer_load_dword a116, v24, s[68:71], s12 offen
    s_mov_b32 s12, 73728
    buffer_load_dword a116, v24, s[68:71], s12 offen
    s_mov_b32 s12, 81920
    buffer_load_dword a116, v24, s[68:71], s12 offen
    s_mov_b32 s12, 90112
    buffer_load_dword a116, v24, s[68:71], s12 offen
    s_mov_b32 s12, 98304
    buffer_load_dword a116, v24, s[68:71], s12 offen
    s_mov_b32 s12, 106496
    buffer_load_dword a116, v24, s[68:71], s12 offen
L_fin:
    s_waitcnt vmcnt(0)
    s_endpgm

L_epoch:
    v_mov_b32 v2, 0
    buffer_load_dword v7, v2, s[80:83], 0 offen sc1
    s_waitcnt vmcnt(0)
    v_cmp_eq_u32 vcc, 0, v7
    s_add_u32 s13, s13, 1
    s_cbranch_vccz L_epoch_done
    s_cmp_lt_u32 s13, 0x10000
    s_cbranch_scc1 L_epoch
    s_branch L_epoch_done

L_sp0:
    s_load_dwordx16 s[44:59], s[0:1], s27 glc
    s_add_u32 s13, s13, 1
    s_waitcnt lgkmcnt(0)
s_xor_b64 s[44:45], s[44:45], s[22:23]
s_xor_b64 s[46:47], s[46:47], s[22:23]
s_xor_b64 s[48:49], s[48:49], s[22:23]
s_xor_b64 s[50:51], s[50:51], s[22:23]
s_xor_b64 s[52:53], s[52:53], s[22:23]
s_xor_b64 s[54:55], s[54:55], s[22:23]
s_xor_b64 s[56:57], s[56:57], s[22:23]
s_xor_b64 s[58:59], s[58:59], s[22:23]
s_or_b64 s[44:45], s[44:45], s[46:47]
s_or_b64 s[44:45], s[44:45], s[48:49]
s_or_b64 s[44:45], s[44:45], s[50:51]
s_or_b64 s[44:45], s[44:45], s[52:53]
s_or_b64 s[44:45], s[44:45], s[54:55]
s_or_b64 s[44:45], s[44:45], s[56:57]
s_or_b64 s[44:45], s[44:45], s[58:59]
    s_cbranch_scc0 L_sp0_done
    s_cmp_lt_u32 s13, 0x10000
    s_cbranch_scc1 L_sp0
    s_branch L_sp0_done

L_sp1:
    s_load_dwordx16 s[44:59], s[0:1], s28 glc
    s_add_u32 s13, s13, 1
    s_waitcnt lgkmcnt(0)
s_xor_b64 s[44:45], s[44:45], s[22:23]
s_xor_b64 s[46:47], s[46:47], s[22:23]
s_xor_b64 s[48:49], s[48:49], s[22:23]
s_xor_b64 s[50:51], s[50:51], s[22:23]
s_xor_b64 s[52:53], s[52:53], s[22:23]
s_or_b64 s[44:45], s[44:45], s[46:47]
s_or_b64 s[44:45], s[44:45], s[48:49]
s_or_b64 s[44:45], s[44:45], s[50:51]
s_or_b64 s[44:45], s[44:45], s[52:53]
    s_cbranch_scc0 L_sp1_done
    s_cmp_lt_u32 s13, 0x10000
    s_cbranch_scc1 L_sp1
    s_branch L_sp1_done

L_sp3:
    s_load_dwordx16 s[44:59], s[0:1], s27 glc
    s_add_u32 s13, s13, 1
    s_waitcnt lgkmcnt(0)
s_xor_b64 s[44:45], s[44:45], s[22:23]
s_xor_b64 s[46:47], s[46:47], s[22:23]
s_xor_b64 s[48:49], s[48:49], s[22:23]
s_or_b64 s[44:45], s[44:45], s[46:47]
s_or_b64 s[44:45], s[44:45], s[48:49]
    s_cbranch_scc0 L_sp3_done
    s_cmp_lt_u32 s13, 0x10000
    s_cbranch_scc1 L_sp3
    s_branch L_sp3_done

L_sp2:
    s_load_dwordx16 s[44:59], s[0:1], s31 glc
    s_add_u32 s13, s13, 1
    s_waitcnt lgkmcnt(0)
s_xor_b64 s[44:45], s[44:45], s[22:23]
s_xor_b64 s[46:47], s[46:47], s[22:23]
s_xor_b64 s[48:49], s[48:49], s[22:23]
s_xor_b64 s[50:51], s[50:51], s[22:23]
s_xor_b64 s[52:53], s[52:53], s[22:23]
s_xor_b64 s[54:55], s[54:55], s[22:23]
s_xor_b64 s[56:57], s[56:57], s[22:23]
s_or_b64 s[44:45], s[44:45], s[46:47]
s_or_b64 s[44:45], s[44:45], s[48:49]
s_or_b64 s[44:45], s[44:45], s[50:51]
s_or_b64 s[44:45], s[44:45], s[52:53]
s_or_b64 s[44:45], s[44:45], s[54:55]
s_or_b64 s[44:45], s[44:45], s[56:57]
    s_cbranch_scc0 L_sp2_done
    s_cmp_lt_u32 s13, 0x10000
    s_cbranch_scc1 L_sp2
    s_branch L_sp2_done

L_poll3:
    buffer_load_dword v8, v9, s[60:63], s28 offen sc1
    s_waitcnt vmcnt(0)
    v_cmp_ne_u32 vcc, v8, v7
    s_add_u32 s13, s13, 1
    s_cbranch_vccz L_poll3_done
    s_cmp_lt_u32 s13, 0x10000
    s_cbranch_scc1 L_poll3
    s_branch L_poll3_done

L_poll4:
    buffer_load_dword v8, v9, s[60:63], s28 offen sc1
    s_waitcnt vmcnt(0)
    v_cmp_ne_u32 vcc, v8, v7
    s_add_u32 s13, s13, 1
    s_cbranch_vccz L_poll4_done
    s_cmp_lt_u32 s13, 0x10000
    s_cbranch_scc1 L_poll4
    s_branch L_poll4_done

L_poll5:
    buffer_load_dword v8, v9, s[60:63], s28 offen sc1
    s_waitcnt vmcnt(0)
    v_cmp_ne_u32 vcc, v8, v7
    s_add_u32 s13, s13, 1
    s_cbranch_vccz L_poll5_done
    s_cmp_lt_u32 s13, 0x10000
    s_cbranch_scc1 L_poll5
    s_branch L_poll5_done

L_poll6:
    buffer_load_dword v8, v9, s[60:63], s28 offen sc1
    s_waitcnt vmcnt(0)
    v_cmp_ne_u32 vcc, v8, v7
    s_add_u32 s13, s13, 1
    s_cbranch_vccz L_poll6_done
    s_cmp_lt_u32 s13, 0x10000
    s_cbranch_scc1 L_poll6
    s_branch L_poll6_done

L_end:
    s_endpgm
.section .rodata,"a"
.p2align 6
.amdhsa_kernel sequential_preLN__linear_kernel_hedgehog__mixer_channel_mlp__prompt_kernel
  .amdhsa_next_free_vgpr 512
  .amdhsa_next_free_sgpr 102
  .amdhsa_accum_offset 256
  .amdhsa_group_segment_fixed_size 0
  .amdhsa_kernarg_size 96
  .amdhsa_user_sgpr_count 2
  .amdhsa_user_sgpr_kernarg_segment_ptr 1
  .amdhsa_system_sgpr_workgroup_id_x 1
.end_amdhsa_kernel
```
